```python
import torch

def _softmax(x, axis=-1):
    return torch.softmax(x, dim=axis)
def _gelu(x):
    return torch.nn.functional.gelu(x, approximate="tanh")
def _silu(x):
    return torch.nn.functional.silu(x)
def _sigmoid(x):
    return torch.sigmoid(x)
def _layernorm(x, axis=-1, eps=1e-5):
    m = x.mean(dim=axis, keepdim=True)
    v = x.var(dim=axis, keepdim=True, unbiased=False)
    return (x - m) / torch.sqrt(v + eps)
def _scatter_add(tgt, idx, src, axis=0):
    return tgt.clone().index_add_(axis, idx, src)
def _segment_sum(src, seg, n):
    out = torch.zeros((n,) + src.shape[1:], dtype=src.dtype)
    return out.index_add_(0, seg, src)
def _pad(x, pw):
    flat = tuple(v for pair in reversed(pw) for v in pair)
    return torch.nn.functional.pad(x, flat)

kernel_name = 'standalone__gqa_softmax__near_ridge'

def setup_inputs():

    _w = (lambda a: (lambda t: t.to(torch.bfloat16) if t.is_floating_point() else t)(torch.as_tensor(a)))
    B, Hq, Hkv, Sq, Sk, D = 8, 32, 8, 128, 512, 128
    return {
        "q": _w((lambda *s: torch.randn(*s, dtype=torch.bfloat16) * 0.8)(B, Hq, Sq, D)),
        "k": _w((lambda *s: torch.randn(*s, dtype=torch.bfloat16) * 0.8)(B, Hkv, Sk, D)),
        "v": _w((lambda *s: torch.randn(*s, dtype=torch.bfloat16) * 0.05)(B, Hkv, Sk, D)),
    }

def reference(q, k, v):
    B, Hq, Sq, D = q.shape
    Hkv = k.shape[1]
    rep = Hq // Hkv
    k = (lambda x, n, axis: torch.repeat_interleave(x, n, dim=axis))(k, rep, axis=1)
    v = (lambda x, n, axis: torch.repeat_interleave(x, n, dim=axis))(v, rep, axis=1)
    scale = D ** -0.5
    scores = torch.einsum("bhqd,bhkd->bhqk", q, k) * scale
    p = _softmax(scores, axis=-1)
    return torch.einsum("bhqk,bhkd->bhqd", p, v)
```

```asm
; @launch grid=(256,1,1) block=(256,1,1) lds=163840
.amdgcn_target "amdgcn-amd-amdhsa--gfx950"
.text
.globl standalone__gqa_softmax__near_ridge_kernel
.p2align 8
.type standalone__gqa_softmax__near_ridge_kernel,@function
standalone__gqa_softmax__near_ridge_kernel:
    s_cmp_ge_u32 s2, 256
    s_cbranch_scc1 L_done
    s_load_dwordx8 s[4:11], s[0:1], 0
    s_getpc_b64 s[40:41]
L_pc:
    v_lshlrev_b32 v244, 7, v0
    v_min_u32 v244, L_done-L_pc, v244
    global_load_dword v191, v244, s[40:41]
    s_and_b32 s28, s2, 7
    s_lshr_b32 s29, s2, 3
    s_and_b32 s29, s29, 3
    s_lshr_b32 s30, s2, 5
    s_lshl_b32 s31, s28, 3
    s_add_u32 s31, s31, s30
    s_lshl_b32 s32, s31, 2
    s_add_u32 s32, s32, s29
    s_lshl_b32 s32, s32, 15
    s_lshl_b32 s33, s31, 17
    v_lshrrev_b32 v245, 6, v0
    v_and_b32 v190, 63, v0
    v_readfirstlane_b32 s34, v245
    s_lshl_b32 s35, s34, 11
    s_lshl_b32 s37, s34, 12
    s_add_u32 s38, s32, s37
    s_add_u32 s39, s38, 4096
    v_lshrrev_b32 v247, 3, v190
    v_and_b32 v245, 7, v190
    v_lshrrev_b32 v246, 4, v190
    v_lshl_add_u32 v247, v247, 8, s37
    v_xor_b32 v248, v246, v245
    v_lshl_add_u32 v242, v248, 4, v247
    v_xor_b32 v243, 2112, v242
    v_and_b32 v246, 1, v246
    v_lshlrev_b32 v246, 2, v246
    v_xor_b32 v246, v246, v245
    v_lshl_add_u32 v248, v246, 4, v247
    s_lshl_b32 s30, s29, 31
    s_mov_b32 s30, 0
    s_waitcnt lgkmcnt(0)
    s_mov_b32 s12, s4
    s_and_b32 s13, s5, 0xffff
    s_mov_b32 s14, 0x800000
    s_mov_b32 s15, 0x00020000
    s_mov_b32 s16, s6
    s_and_b32 s17, s7, 0xffff
    s_mov_b32 s18, 0x800000
    s_mov_b32 s19, 0x00020000
    s_mov_b32 s20, s8
    s_and_b32 s21, s9, 0xffff
    s_mov_b32 s22, 0x800000
    s_mov_b32 s23, 0x00020000
    s_mov_b32 s24, s10
    s_and_b32 s25, s11, 0xffff
    s_mov_b32 s26, 0x800000
    s_mov_b32 s27, 0x00020000
    s_add_u32 s36, s30, 0
    s_and_b32 s36, s36, 0x1ffff
    s_add_u32 s4, s33, s36
    s_add_u32 m0, s37, 0
    s_nop 0
    buffer_load_dwordx4 v242, s[12:15], s38 offen lds
    s_add_u32 m0, s37, 1024
    s_nop 0
    buffer_load_dwordx4 v243, s[12:15], s38 offen lds
    s_add_u32 m0, s37, 2048
    s_nop 0
    buffer_load_dwordx4 v242, s[12:15], s39 offen lds
    s_add_u32 m0, s37, 3072
    s_nop 0
    buffer_load_dwordx4 v243, s[12:15], s39 offen lds
    s_add_u32 m0, s35, 32768
    s_nop 0
    buffer_load_dwordx4 v242, s[16:19], s4 offen lds
    s_add_u32 m0, s35, 33792
    s_nop 0
    buffer_load_dwordx4 v243, s[16:19], s4 offen lds
    s_add_u32 s36, s30, 16384
    s_and_b32 s36, s36, 0x1ffff
    s_add_u32 s5, s33, s36
    s_add_u32 m0, s35, 40960
    s_nop 0
    buffer_load_dwordx4 v242, s[16:19], s5 offen lds
    s_add_u32 m0, s35, 41984
    s_nop 0
    buffer_load_dwordx4 v243, s[16:19], s5 offen lds
    s_add_u32 s36, s30, 32768
    s_and_b32 s36, s36, 0x1ffff
    s_add_u32 s6, s33, s36
    s_add_u32 m0, s35, 49152
    s_nop 0
    buffer_load_dwordx4 v242, s[16:19], s6 offen lds
    s_add_u32 m0, s35, 50176
    s_nop 0
    buffer_load_dwordx4 v243, s[16:19], s6 offen lds
    v_and_b32 v244, 31, v190
    v_lshrrev_b32 v245, 5, v190
    v_bfe_u32 v246, v190, 1, 3
    v_xor_b32 v246, v246, v245
    v_lshlrev_b32 v247, 7, v244
    v_xor_b32 v224, 0, v246
    v_lshl_add_u32 v224, v224, 4, v247
    v_add_u32 v228, 65536, v224
    v_add_u32 v232, 131072, v224
    v_xor_b32 v225, 2, v246
    v_lshl_add_u32 v225, v225, 4, v247
    v_add_u32 v229, 65536, v225
    v_add_u32 v233, 131072, v225
    v_xor_b32 v226, 4, v246
    v_lshl_add_u32 v226, v226, 4, v247
    v_add_u32 v230, 65536, v226
    v_add_u32 v234, 131072, v226
    v_xor_b32 v227, 6, v246
    v_lshl_add_u32 v227, v227, 4, v247
    v_add_u32 v231, 65536, v227
    v_add_u32 v235, 131072, v227
    s_lshl_b32 s36, s34, 13
    v_lshl_add_u32 v249, v244, 8, s36
    v_lshl_add_u32 v249, v245, 4, v249
    v_bfe_u32 v246, v190, 2, 2
    v_lshl_add_u32 v247, v245, 2, v246
    v_lshlrev_b32 v247, 7, v247
    v_bfe_u32 v244, v190, 4, 1
    v_lshl_add_u32 v247, v244, 4, v247
    v_and_b32 v244, 1, v190
    v_lshl_add_u32 v247, v244, 5, v247
    v_bfe_u32 v244, v190, 1, 1
    v_lshl_add_u32 v247, v244, 3, v247
    s_add_u32 s28, s35, 139264
    s_add_u32 s42, s32, 4096
    v_bfe_u32 v254, v190, 1, 2
    v_bfe_u32 v244, v190, 3, 1
    v_xor_b32 v254, v254, v244
    v_lshlrev_b32 v244, 1, v245
    v_xor_b32 v254, v254, v244
    v_lshl_add_u32 v254, v254, 4, s28
    v_and_b32 v244, 31, v190
    v_lshl_add_u32 v254, v244, 6, v254
    v_bfe_u32 v255, v190, 3, 2
    v_xor_b32 v255, v255, v245
    v_and_b32 v244, 3, v190
    v_xor_b32 v255, v255, v244
    v_lshl_add_u32 v255, v255, 4, s28
    v_lshrrev_b32 v251, 2, v190
    v_lshl_add_u32 v255, v251, 6, v255
    v_lshl_add_u32 v251, v251, 8, s36
    v_lshl_add_u32 v251, v244, 4, v251
    v_lshlrev_b32 v253, 2, v244
    v_add_u32 v253, 155648, v253
    v_bfe_u32 v244, v190, 3, 1
    v_lshl_add_u32 v236, v244, 6, v247
    v_xor_b32 v237, 64, v236
    v_add_u32 v238, 65536, v236
    v_add_u32 v240, 131072, v236
    v_add_u32 v239, 65536, v237
    v_add_u32 v241, 131072, v237
    v_and_b32 v244, 4, v190
    v_cmp_eq_u32 vcc, 0, v244
    v_mov_b32 v245, 0x3f803f80
    s_nop 0
    v_cndmask_b32 v244, 0, v245, vcc
    v_xor_b32 v245, v245, v244
    v_accvgpr_write_b32 a32, v244
    v_accvgpr_write_b32 a33, v244
    v_accvgpr_write_b32 a34, v245
    v_accvgpr_write_b32 a35, v245
    v_and_b32 v244, 1, v190
    v_mul_u32_u24 v244, 0xaaaa, v244
    v_or_b32 v244, 0x4444, v244
    v_lshl_or_b32 v249, v244, 16, v244
    v_accvgpr_write_b32 a249, v249
    s_mov_b32 s100, 0x3e0293ee
    s_mov_b32 s101, 0x3e0293ee
    s_add_u32 s36, s30, 49152
    s_and_b32 s36, s36, 0x1ffff
    s_add_u32 s7, s33, s36
    s_add_u32 s36, s30, 65536
    s_and_b32 s36, s36, 0x1ffff
    s_add_u32 s8, s33, s36
    s_add_u32 s36, s30, 81920
    s_and_b32 s36, s36, 0x1ffff
    s_add_u32 s9, s33, s36
    s_add_u32 s36, s30, 98304
    s_and_b32 s36, s36, 0x1ffff
    s_add_u32 s10, s33, s36
    s_add_u32 s36, s30, 114688
    s_and_b32 s36, s36, 0x1ffff
    s_add_u32 s11, s33, s36
    v_accvgpr_write_b32 a36, 0
    v_accvgpr_write_b32 a37, 0
    v_accvgpr_write_b32 a38, 0
    v_accvgpr_write_b32 a39, 0
    s_add_u32 m0, s35, 57344
    s_nop 0
    buffer_load_dwordx4 v242, s[16:19], s7 offen lds
    s_add_u32 m0, s35, 58368
    s_nop 0
    buffer_load_dwordx4 v243, s[16:19], s7 offen lds
    v_add_u32 v244, s37, v224
    v_add_u32 v245, s37, v225
    v_add_u32 v246, s37, v226
    v_add_u32 v247, s37, v227
    s_waitcnt vmcnt(8)
    ds_read_b128 v[192:195], v244 offset:0
    ds_read_b128 v[196:199], v245 offset:0
    ds_read_b128 v[200:203], v246 offset:0
    ds_read_b128 v[204:207], v247 offset:0
    s_waitcnt lgkmcnt(3)
    v_lshlrev_b32 v244, 16, v192
    v_and_b32 v245, 0xffff0000, v192
    v_lshlrev_b32 v246, 16, v193
    v_and_b32 v247, 0xffff0000, v193
    v_pk_mul_f32 v[244:245], v[244:245], s[100:101]
    v_pk_mul_f32 v[246:247], v[246:247], s[100:101]
    v_cvt_pk_bf16_f32 v192, v244, v245
    v_cvt_pk_bf16_f32 v193, v246, v247
    v_accvgpr_write_b32 a0, v192
    v_accvgpr_write_b32 a1, v193
    v_lshlrev_b32 v244, 16, v194
    v_and_b32 v245, 0xffff0000, v194
    v_lshlrev_b32 v246, 16, v195
    v_and_b32 v247, 0xffff0000, v195
    v_pk_mul_f32 v[244:245], v[244:245], s[100:101]
    v_pk_mul_f32 v[246:247], v[246:247], s[100:101]
    v_cvt_pk_bf16_f32 v194, v244, v245
    v_cvt_pk_bf16_f32 v195, v246, v247
    v_accvgpr_write_b32 a2, v194
    v_accvgpr_write_b32 a3, v195
    s_waitcnt vmcnt(6)
    s_barrier
    ds_read_b128 a[40:43], v224 offset:32768
    ds_read_b128 a[44:47], v224 offset:36864
    ds_read_b128 a[48:51], v225 offset:32768
    ds_read_b128 a[52:55], v225 offset:36864
    ds_read_b128 a[56:59], v226 offset:32768
    ds_read_b128 a[60:63], v226 offset:36864
    s_waitcnt lgkmcnt(4)
    v_mfma_f32_32x32x16_bf16 v[0:15], a[40:43], a[0:3], 0
    ds_read_b128 a[64:67], v227 offset:32768
    v_lshlrev_b32 v244, 16, v196
    v_and_b32 v245, 0xffff0000, v196
    v_lshlrev_b32 v246, 16, v197
    v_and_b32 v247, 0xffff0000, v197
    v_mul_f32 v244, s100, v244
    v_mul_f32 v245, s100, v245
    v_mul_f32 v246, s100, v246
    v_mul_f32 v247, s100, v247
    v_cvt_pk_bf16_f32 v196, v244, v245
    v_cvt_pk_bf16_f32 v197, v246, v247
    v_accvgpr_write_b32 a4, v196
    v_accvgpr_write_b32 a5, v197
    v_lshlrev_b32 v244, 16, v198
    v_and_b32 v245, 0xffff0000, v198
    s_add_u32 m0, s35, 65536
    v_mfma_f32_32x32x16_bf16 v[16:31], a[44:47], a[0:3], 0
    ds_read_b128 a[68:71], v227 offset:36864
    buffer_load_dwordx4 v242, s[16:19], s8 offen lds
    v_lshlrev_b32 v246, 16, v199
    v_and_b32 v247, 0xffff0000, v199
    v_mul_f32 v244, s100, v244
    v_mul_f32 v245, s100, v245
    v_mul_f32 v246, s100, v246
    v_mul_f32 v247, s100, v247
    v_cvt_pk_bf16_f32 v198, v244, v245
    v_cvt_pk_bf16_f32 v199, v246, v247
    v_accvgpr_write_b32 a6, v198
    v_accvgpr_write_b32 a7, v199
    s_waitcnt vmcnt(5)
    s_barrier
    s_waitcnt lgkmcnt(4)
    v_mfma_f32_32x32x16_bf16 v[0:15], a[48:51], a[4:7], v[0:15]
    ds_read_b128 a[40:43], v224 offset:40960
    v_lshlrev_b32 v244, 16, v200
    v_and_b32 v245, 0xffff0000, v200
    v_lshlrev_b32 v246, 16, v201
    v_and_b32 v247, 0xffff0000, v201
    v_mul_f32 v244, s100, v244
    v_mul_f32 v245, s100, v245
    v_mul_f32 v246, s100, v246
    v_mul_f32 v247, s100, v247
    v_cvt_pk_bf16_f32 v200, v244, v245
    v_cvt_pk_bf16_f32 v201, v246, v247
    v_accvgpr_write_b32 a8, v200
    v_accvgpr_write_b32 a9, v201
    v_lshlrev_b32 v244, 16, v202
    s_add_u32 m0, s35, 66560
    v_mfma_f32_32x32x16_bf16 v[16:31], a[52:55], a[4:7], v[16:31]
    ds_read_b128 a[44:47], v224 offset:45056
    buffer_load_dwordx4 v243, s[16:19], s8 offen lds
    v_and_b32 v245, 0xffff0000, v202
    v_lshlrev_b32 v246, 16, v203
    v_and_b32 v247, 0xffff0000, v203
    v_mul_f32 v244, s100, v244
    v_mul_f32 v245, s100, v245
    v_mul_f32 v246, s100, v246
    v_mul_f32 v247, s100, v247
    v_cvt_pk_bf16_f32 v202, v244, v245
    v_cvt_pk_bf16_f32 v203, v246, v247
    v_accvgpr_write_b32 a10, v202
    v_accvgpr_write_b32 a11, v203
    s_waitcnt lgkmcnt(4)
    s_nop 0
    v_mfma_f32_32x32x16_bf16 v[0:15], a[56:59], a[8:11], v[0:15]
    ds_read_b128 a[48:51], v225 offset:40960
    v_lshlrev_b32 v244, 16, v204
    v_and_b32 v245, 0xffff0000, v204
    v_lshlrev_b32 v246, 16, v205
    v_and_b32 v247, 0xffff0000, v205
    v_mul_f32 v244, s100, v244
    v_mul_f32 v245, s100, v245
    v_mul_f32 v246, s100, v246
    v_mul_f32 v247, s100, v247
    v_cvt_pk_bf16_f32 v204, v244, v245
    v_cvt_pk_bf16_f32 v205, v246, v247
    v_accvgpr_write_b32 a12, v204
    v_accvgpr_write_b32 a13, v205
    v_lshlrev_b32 v244, 16, v206
    s_add_u32 m0, s35, 73728
    v_mfma_f32_32x32x16_bf16 v[16:31], a[60:63], a[8:11], v[16:31]
    ds_read_b128 a[52:55], v225 offset:45056
    buffer_load_dwordx4 v242, s[16:19], s9 offen lds
    v_and_b32 v245, 0xffff0000, v206
    v_lshlrev_b32 v246, 16, v207
    v_and_b32 v247, 0xffff0000, v207
    v_mul_f32 v244, s100, v244
    v_mul_f32 v245, s100, v245
    v_mul_f32 v246, s100, v246
    v_mul_f32 v247, s100, v247
    v_cvt_pk_bf16_f32 v206, v244, v245
    v_cvt_pk_bf16_f32 v207, v246, v247
    v_accvgpr_write_b32 a14, v206
    v_accvgpr_write_b32 a15, v207
    s_waitcnt lgkmcnt(4)
    s_nop 0
    v_mfma_f32_32x32x16_bf16 v[0:15], a[64:67], a[12:15], v[0:15]
    ds_read_b128 a[56:59], v226 offset:40960
    s_add_u32 m0, s35, 74752
    v_mfma_f32_32x32x16_bf16 v[16:31], a[68:71], a[12:15], v[16:31]
    ds_read_b128 a[60:63], v226 offset:45056
    buffer_load_dwordx4 v243, s[16:19], s9 offen lds
    s_waitcnt lgkmcnt(4)
    v_mfma_f32_32x32x16_bf16 v[32:47], a[40:43], a[0:3], 0
    ds_read_b128 a[64:67], v227 offset:40960
    s_add_u32 m0, s37, 16256
    v_mfma_f32_32x32x16_bf16 v[48:63], a[44:47], a[0:3], 0
    ds_read_b128 a[68:71], v227 offset:45056
    buffer_load_dwordx4 v242, s[12:15], s38 offen offset:128 lds
    s_waitcnt vmcnt(7)
    s_barrier
    s_waitcnt lgkmcnt(4)
    v_mfma_f32_32x32x16_bf16 v[32:47], a[48:51], a[4:7], v[32:47]
    ds_read_b128 a[40:43], v224 offset:49152
    s_add_u32 m0, s37, 17280
    v_mfma_f32_32x32x16_bf16 v[48:63], a[52:55], a[4:7], v[48:63]
    ds_read_b128 a[44:47], v224 offset:53248
    buffer_load_dwordx4 v243, s[12:15], s38 offen offset:128 lds
    s_waitcnt lgkmcnt(4)
    v_mfma_f32_32x32x16_bf16 v[32:47], a[56:59], a[8:11], v[32:47]
    ds_read_b128 a[48:51], v225 offset:49152
    s_add_u32 m0, s37, 18304
    v_mfma_f32_32x32x16_bf16 v[48:63], a[60:63], a[8:11], v[48:63]
    ds_read_b128 a[52:55], v225 offset:53248
    buffer_load_dwordx4 v242, s[12:15], s39 offen offset:128 lds
    s_waitcnt lgkmcnt(4)
    v_mfma_f32_32x32x16_bf16 v[32:47], a[64:67], a[12:15], v[32:47]
    ds_read_b128 a[56:59], v226 offset:49152
    s_add_u32 m0, s37, 19328
    v_mfma_f32_32x32x16_bf16 v[48:63], a[68:71], a[12:15], v[48:63]
    ds_read_b128 a[60:63], v226 offset:53248
    buffer_load_dwordx4 v243, s[12:15], s39 offen offset:128 lds
    s_waitcnt lgkmcnt(4)
    v_mfma_f32_32x32x16_bf16 v[64:79], a[40:43], a[0:3], 0
    ds_read_b128 a[64:67], v227 offset:49152
    s_add_u32 m0, s35, 81792
    v_mfma_f32_32x32x16_bf16 v[80:95], a[44:47], a[0:3], 0
    ds_read_b128 a[68:71], v227 offset:53248
    buffer_load_dwordx4 v242, s[16:19], s4 offen offset:128 lds
    s_waitcnt vmcnt(9)
    s_barrier
    s_waitcnt lgkmcnt(4)
    v_mfma_f32_32x32x16_bf16 v[64:79], a[48:51], a[4:7], v[64:79]
    ds_read_b128 a[40:43], v224 offset:57344
    s_add_u32 m0, s35, 82816
    v_mfma_f32_32x32x16_bf16 v[80:95], a[52:55], a[4:7], v[80:95]
    ds_read_b128 a[44:47], v224 offset:61440
    buffer_load_dwordx4 v243, s[16:19], s4 offen offset:128 lds
    s_waitcnt lgkmcnt(4)
    v_mfma_f32_32x32x16_bf16 v[64:79], a[56:59], a[8:11], v[64:79]
    ds_read_b128 a[48:51], v225 offset:57344
    s_add_u32 m0, s35, 89984
    v_mfma_f32_32x32x16_bf16 v[80:95], a[60:63], a[8:11], v[80:95]
    ds_read_b128 a[52:55], v225 offset:61440
    buffer_load_dwordx4 v242, s[16:19], s5 offen offset:128 lds
    s_waitcnt lgkmcnt(4)
    v_mfma_f32_32x32x16_bf16 v[64:79], a[64:67], a[12:15], v[64:79]
    ds_read_b128 a[56:59], v226 offset:57344
    s_add_u32 m0, s35, 91008
    v_mfma_f32_32x32x16_bf16 v[80:95], a[68:71], a[12:15], v[80:95]
    ds_read_b128 a[60:63], v226 offset:61440
    buffer_load_dwordx4 v243, s[16:19], s5 offen offset:128 lds
    s_add_u32 m0, s35, 98176
    s_waitcnt lgkmcnt(4)
    v_mfma_f32_32x32x16_bf16 v[96:111], a[40:43], a[0:3], 0
    ds_read_b128 a[64:67], v227 offset:57344
    buffer_load_dwordx4 v242, s[16:19], s6 offen offset:128 lds
    s_add_u32 m0, s35, 99200
    v_mfma_f32_32x32x16_bf16 v[112:127], a[44:47], a[0:3], 0
    ds_read_b128 a[68:71], v227 offset:61440
    buffer_load_dwordx4 v243, s[16:19], s6 offen offset:128 lds
    s_waitcnt vmcnt(12)
    s_barrier
    s_add_u32 m0, s35, 106496
    s_waitcnt lgkmcnt(4)
    v_mfma_f32_32x32x16_bf16 v[96:111], a[48:51], a[4:7], v[96:111]
    ds_read_b128 a[40:43], v228 offset:0
    buffer_load_dwordx4 v248, s[20:23], s4 offen lds
    s_add_u32 m0, s35, 105472
    v_mfma_f32_32x32x16_bf16 v[112:127], a[52:55], a[4:7], v[112:127]
    ds_read_b128 a[44:47], v228 offset:4096
    buffer_load_dwordx4 v248, s[20:23], s4 offen offset:2048 lds
    s_add_u32 m0, s35, 114560
    s_waitcnt lgkmcnt(4)
    v_mfma_f32_32x32x16_bf16 v[96:111], a[56:59], a[8:11], v[96:111]
    ds_read_b128 a[48:51], v229 offset:0
    buffer_load_dwordx4 v242, s[16:19], s7 offen offset:128 lds
    s_add_u32 m0, s35, 115584
    v_mfma_f32_32x32x16_bf16 v[112:127], a[60:63], a[8:11], v[112:127]
    ds_read_b128 a[52:55], v229 offset:4096
    buffer_load_dwordx4 v243, s[16:19], s7 offen offset:128 lds
    s_add_u32 m0, s35, 122752
    s_waitcnt lgkmcnt(4)
    v_mfma_f32_32x32x16_bf16 v[96:111], a[64:67], a[12:15], v[96:111]
    ds_read_b128 a[56:59], v230 offset:0
    buffer_load_dwordx4 v248, s[20:23], s4 offen offset:128 lds
    s_add_u32 m0, s35, 121728
    v_mfma_f32_32x32x16_bf16 v[112:127], a[68:71], a[12:15], v[112:127]
    ds_read_b128 a[60:63], v230 offset:4096
    buffer_load_dwordx4 v248, s[20:23], s4 offen offset:2176 lds
    s_add_u32 m0, s35, 131072
    s_waitcnt lgkmcnt(4)
    v_mfma_f32_32x32x16_bf16 v[128:143], a[40:43], a[0:3], 0
    ds_read_b128 a[64:67], v231 offset:0
    buffer_load_dwordx4 v248, s[20:23], s5 offen lds
    s_add_u32 m0, s35, 130048
    v_mfma_f32_32x32x16_bf16 v[144:159], a[44:47], a[0:3], 0
    ds_read_b128 a[68:71], v231 offset:4096
    buffer_load_dwordx4 v248, s[20:23], s5 offen offset:2048 lds
    s_waitcnt vmcnt(12)
    s_barrier
    s_add_u32 m0, s35, 139136
    s_waitcnt lgkmcnt(4)
    v_mfma_f32_32x32x16_bf16 v[128:143], a[48:51], a[4:7], v[128:143]
    ds_read_b128 a[40:43], v228 offset:8192
    buffer_load_dwordx4 v248, s[20:23], s5 offen offset:128 lds
    s_add_u32 m0, s35, 138112
    v_mfma_f32_32x32x16_bf16 v[144:159], a[52:55], a[4:7], v[144:159]
    ds_read_b128 a[44:47], v228 offset:12288
    buffer_load_dwordx4 v248, s[20:23], s5 offen offset:2176 lds
    s_add_u32 m0, s35, 147328
    s_waitcnt lgkmcnt(4)
    v_mfma_f32_32x32x16_bf16 v[128:143], a[56:59], a[8:11], v[128:143]
    ds_read_b128 a[48:51], v229 offset:8192
    buffer_load_dwordx4 v242, s[16:19], s8 offen offset:128 lds
    s_add_u32 m0, s35, 148352
    v_mfma_f32_32x32x16_bf16 v[144:159], a[60:63], a[8:11], v[144:159]
    ds_read_b128 a[52:55], v229 offset:12288
    buffer_load_dwordx4 v243, s[16:19], s8 offen offset:128 lds
    v_add_u32 v244, s37, v224
    v_add_u32 v245, s37, v225
    v_add_u32 v246, s37, v226
    v_add_u32 v247, s37, v227
    s_waitcnt lgkmcnt(4)
    v_mfma_f32_32x32x16_bf16 v[128:143], a[64:67], a[12:15], v[128:143]
    ds_read_b128 a[56:59], v230 offset:8192
    s_waitcnt vmcnt(18)
    ds_read_b128 v[192:195], v244 offset:16384
    ds_read_b128 v[196:199], v245 offset:16384
    ds_read_b128 v[200:203], v246 offset:16384
    ds_read_b128 v[204:207], v247 offset:16384
    s_add_u32 m0, s35, 8192
    v_mfma_f32_32x32x16_bf16 v[144:159], a[68:71], a[12:15], v[144:159]
    ds_read_b128 a[60:63], v230 offset:12288
    buffer_load_dwordx4 v248, s[20:23], s6 offen lds
    s_waitcnt lgkmcnt(8)
    v_mfma_f32_32x32x16_bf16 v[160:175], a[40:43], a[0:3], 0
    ds_read_b128 a[64:67], v231 offset:8192
    s_waitcnt lgkmcnt(5)
    v_lshlrev_b32 v244, 16, v192
    v_and_b32 v245, 0xffff0000, v192
    v_lshlrev_b32 v246, 16, v193
    v_and_b32 v247, 0xffff0000, v193
    v_mul_f32 v244, s100, v244
    v_mul_f32 v245, s100, v245
    v_mul_f32 v246, s100, v246
    v_mul_f32 v247, s100, v247
    v_cvt_pk_bf16_f32 v192, v244, v245
    s_add_u32 m0, s35, 7168
    v_mfma_f32_32x32x16_bf16 v[176:191], a[44:47], a[0:3], 0
    ds_read_b128 a[68:71], v231 offset:12288
    buffer_load_dwordx4 v248, s[20:23], s6 offen offset:2048 lds
    v_cvt_pk_bf16_f32 v193, v246, v247
    v_accvgpr_write_b32 a16, v192
    v_accvgpr_write_b32 a17, v193
    v_lshlrev_b32 v244, 16, v194
    v_and_b32 v245, 0xffff0000, v194
    v_lshlrev_b32 v246, 16, v195
    v_mfma_f32_32x32x16_bf16 v[160:175], a[48:51], a[4:7], v[160:175]
    ds_read_b128 a[40:43], v228 offset:16384
    v_and_b32 v247, 0xffff0000, v195
    v_mul_f32 v244, s100, v244
    v_mul_f32 v245, s100, v245
    v_mul_f32 v246, s100, v246
    v_mul_f32 v247, s100, v247
    v_cvt_pk_bf16_f32 v194, v244, v245
    v_cvt_pk_bf16_f32 v195, v246, v247
    v_accvgpr_write_b32 a18, v194
    v_accvgpr_write_b32 a19, v195
    s_add_u32 m0, s35, 32640
    v_mfma_f32_32x32x16_bf16 v[176:191], a[52:55], a[4:7], v[176:191]
    ds_read_b128 a[44:47], v228 offset:20480
    buffer_load_dwordx4 v248, s[20:23], s6 offen offset:128 lds
    s_waitcnt lgkmcnt(7)
    v_lshlrev_b32 v244, 16, v196
    v_and_b32 v245, 0xffff0000, v196
    v_lshlrev_b32 v246, 16, v197
    v_and_b32 v247, 0xffff0000, v197
    v_mul_f32 v244, s100, v244
    v_mul_f32 v245, s100, v245
    s_waitcnt lgkmcnt(4)
    v_mfma_f32_32x32x16_bf16 v[160:175], a[56:59], a[8:11], v[160:175]
    ds_read_b128 a[48:51], v229 offset:16384
    v_mul_f32 v246, s100, v246
    v_mul_f32 v247, s100, v247
    v_cvt_pk_bf16_f32 v196, v244, v245
    v_cvt_pk_bf16_f32 v197, v246, v247
    v_accvgpr_write_b32 a20, v196
    v_accvgpr_write_b32 a21, v197
    v_lshlrev_b32 v244, 16, v198
    v_and_b32 v245, 0xffff0000, v198
    v_lshlrev_b32 v246, 16, v199
    s_add_u32 m0, s35, 31616
    v_mfma_f32_32x32x16_bf16 v[176:191], a[60:63], a[8:11], v[176:191]
    ds_read_b128 a[52:55], v229 offset:20480
    buffer_load_dwordx4 v248, s[20:23], s6 offen offset:2176 lds
    v_and_b32 v247, 0xffff0000, v199
    v_mul_f32 v244, s100, v244
    v_mul_f32 v245, s100, v245
    v_mul_f32 v246, s100, v246
    s_waitcnt vmcnt(18)
    s_barrier
    s_waitcnt lgkmcnt(4)
    v_mfma_f32_32x32x16_bf16 v[160:175], a[64:67], a[12:15], v[160:175]
    ds_read_b128 a[56:59], v230 offset:16384
    v_mul_f32 v247, s100, v247
    v_cvt_pk_bf16_f32 v198, v244, v245
    v_cvt_pk_bf16_f32 v199, v246, v247
    v_accvgpr_write_b32 a22, v198
    v_accvgpr_write_b32 a23, v199
    v_lshlrev_b32 v244, 16, v200
    v_and_b32 v245, 0xffff0000, v200
    v_lshlrev_b32 v246, 16, v201
    v_and_b32 v247, 0xffff0000, v201
    s_add_u32 m0, s35, 40960
    v_mfma_f32_32x32x16_bf16 v[176:191], a[68:71], a[12:15], v[176:191]
    ds_read_b128 a[60:63], v230 offset:20480
    buffer_load_dwordx4 v248, s[20:23], s7 offen lds
    v_mul_f32 v244, s100, v244
    v_mul_f32 v245, s100, v245
    v_mul_f32 v246, s100, v246
    v_mul_f32 v247, s100, v247
    v_cvt_pk_bf16_f32 v200, v244, v245
    v_cvt_pk_bf16_f32 v201, v246, v247
    s_waitcnt lgkmcnt(4)
    v_mfma_f32_32x32x16_bf16 v[0:15], a[40:43], a[16:19], v[0:15]
    ds_read_b128 a[64:67], v231 offset:16384
    v_accvgpr_write_b32 a24, v200
    v_accvgpr_write_b32 a25, v201
    v_lshlrev_b32 v244, 16, v202
    v_and_b32 v245, 0xffff0000, v202
    v_lshlrev_b32 v246, 16, v203
    v_and_b32 v247, 0xffff0000, v203
    v_mul_f32 v244, s100, v244
    v_mul_f32 v245, s100, v245
    v_mul_f32 v246, s100, v246
    s_add_u32 m0, s35, 39936
    v_mfma_f32_32x32x16_bf16 v[16:31], a[44:47], a[16:19], v[16:31]
    ds_read_b128 a[68:71], v231 offset:20480
    buffer_load_dwordx4 v248, s[20:23], s7 offen offset:2048 lds
    v_mul_f32 v247, s100, v247
    v_cvt_pk_bf16_f32 v202, v244, v245
    v_cvt_pk_bf16_f32 v203, v246, v247
    v_accvgpr_write_b32 a26, v202
    v_accvgpr_write_b32 a27, v203
    v_lshlrev_b32 v244, 16, v204
    s_waitcnt lgkmcnt(4)
    v_mfma_f32_32x32x16_bf16 v[0:15], a[48:51], a[20:23], v[0:15]
    ds_read_b128 a[40:43], v228 offset:24576
    v_and_b32 v245, 0xffff0000, v204
    v_lshlrev_b32 v246, 16, v205
    v_and_b32 v247, 0xffff0000, v205
    v_mul_f32 v244, s100, v244
    v_mul_f32 v245, s100, v245
    v_mul_f32 v246, s100, v246
    v_mul_f32 v247, s100, v247
    v_cvt_pk_bf16_f32 v204, v244, v245
    v_cvt_pk_bf16_f32 v205, v246, v247
    s_add_u32 m0, s35, 49024
    v_mfma_f32_32x32x16_bf16 v[16:31], a[52:55], a[20:23], v[16:31]
    ds_read_b128 a[44:47], v228 offset:28672
    buffer_load_dwordx4 v248, s[20:23], s7 offen offset:128 lds
    v_accvgpr_write_b32 a28, v204
    v_accvgpr_write_b32 a29, v205
    v_lshlrev_b32 v244, 16, v206
    v_and_b32 v245, 0xffff0000, v206
    v_lshlrev_b32 v246, 16, v207
    v_and_b32 v247, 0xffff0000, v207
    s_waitcnt lgkmcnt(4)
    v_mfma_f32_32x32x16_bf16 v[0:15], a[56:59], a[24:27], v[0:15]
    ds_read_b128 a[48:51], v229 offset:24576
    v_mul_f32 v244, s100, v244
    v_mul_f32 v245, s100, v245
    v_mul_f32 v246, s100, v246
    v_mul_f32 v247, s100, v247
    v_cvt_pk_bf16_f32 v206, v244, v245
    v_cvt_pk_bf16_f32 v207, v246, v247
    v_accvgpr_write_b32 a30, v206
    v_accvgpr_write_b32 a31, v207
    s_add_u32 m0, s35, 48000
    v_mfma_f32_32x32x16_bf16 v[16:31], a[60:63], a[24:27], v[16:31]
    ds_read_b128 a[52:55], v229 offset:28672
    buffer_load_dwordx4 v248, s[20:23], s7 offen offset:2176 lds
    s_waitcnt lgkmcnt(4)
    v_mfma_f32_32x32x16_bf16 v[0:15], a[64:67], a[28:31], v[0:15]
    ds_read_b128 a[56:59], v230 offset:24576
    s_add_u32 m0, s35, 57216
    v_mfma_f32_32x32x16_bf16 v[16:31], a[68:71], a[28:31], v[16:31]
    ds_read_b128 a[60:63], v230 offset:28672
    buffer_load_dwordx4 v242, s[16:19], s9 offen offset:128 lds
    s_waitcnt lgkmcnt(4)
    v_mfma_f32_32x32x16_bf16 v[32:47], a[40:43], a[16:19], v[32:47]
    ds_read_b128 a[64:67], v231 offset:24576
    s_add_u32 m0, s35, 58240
    v_mfma_f32_32x32x16_bf16 v[48:63], a[44:47], a[16:19], v[48:63]
    ds_read_b128 a[68:71], v231 offset:28672
    buffer_load_dwordx4 v243, s[16:19], s9 offen offset:128 lds
    s_waitcnt vmcnt(18)
    s_barrier
    s_waitcnt lgkmcnt(4)
    v_mfma_f32_32x32x16_bf16 v[32:47], a[48:51], a[20:23], v[32:47]
    ds_read_b128 a[40:43], v228 offset:32768
    v_exp_f32 v0, v0
    v_exp_f32 v1, v1
    v_exp_f32 v2, v2
    s_add_u32 m0, s35, 16384
    v_mfma_f32_32x32x16_bf16 v[48:63], a[52:55], a[20:23], v[48:63]
    ds_read_b128 a[44:47], v228 offset:36864
    buffer_load_dwordx4 v248, s[20:23], s8 offen lds
    v_exp_f32 v3, v3
    v_cvt_pk_bf16_f32 v0, v0, v1
    s_waitcnt lgkmcnt(4)
    v_mfma_f32_32x32x16_bf16 v[32:47], a[56:59], a[24:27], v[32:47]
    ds_read_b128 a[48:51], v229 offset:32768
    v_exp_f32 v4, v4
    v_exp_f32 v5, v5
    v_cvt_pk_bf16_f32 v1, v2, v3
    s_add_u32 m0, s35, 15360
    v_mfma_f32_32x32x16_bf16 v[48:63], a[60:63], a[24:27], v[48:63]
    ds_read_b64_tr_b16 a[52:53], v238 offset:40960
    ds_read_b64_tr_b16 a[54:55], v238 offset:41984
    buffer_load_dwordx4 v248, s[20:23], s8 offen offset:2048 lds
    v_exp_f32 v6, v6
    s_waitcnt lgkmcnt(5)
    v_mfma_f32_32x32x16_bf16 v[32:47], a[64:67], a[28:31], v[32:47]
    ds_read_b64_tr_b16 a[56:57], v239 offset:40960
    ds_read_b64_tr_b16 a[58:59], v239 offset:41984
    v_exp_f32 v7, v7
    v_cvt_pk_bf16_f32 v2, v4, v5
    v_exp_f32 v8, v8
    s_add_u32 m0, s35, 24448
    v_mfma_f32_32x32x16_bf16 v[48:63], a[68:71], a[28:31], v[48:63]
    ds_read_b64_tr_b16 a[60:61], v238 offset:43008
    ds_read_b64_tr_b16 a[62:63], v238 offset:44032
    buffer_load_dwordx4 v248, s[20:23], s8 offen offset:128 lds
    v_exp_f32 v9, v9
    s_waitcnt lgkmcnt(7)
    v_mfma_f32_32x32x16_bf16 v[64:79], a[40:43], a[16:19], v[64:79]
    ds_read_b64_tr_b16 a[64:65], v239 offset:43008
    ds_read_b64_tr_b16 a[66:67], v239 offset:44032
    v_cvt_pk_bf16_f32 v3, v6, v7
    v_exp_f32 v10, v10
    v_exp_f32 v11, v11
    s_add_u32 m0, s35, 23424
    v_mfma_f32_32x32x16_bf16 v[80:95], a[44:47], a[16:19], v[80:95]
    ds_read_b128 a[68:71], v230 offset:32768
    buffer_load_dwordx4 v248, s[20:23], s8 offen offset:2176 lds
    v_cvt_pk_bf16_f32 v4, v8, v9
    v_exp_f32 v12, v12
    s_waitcnt lgkmcnt(7)
    v_mfma_f32_32x32x16_bf16 v[64:79], a[48:51], a[20:23], v[64:79]
    ds_read_b128 a[40:43], v229 offset:36864
    v_exp_f32 v13, v13
    v_cvt_pk_bf16_f32 v5, v10, v11
    v_exp_f32 v14, v14
    s_add_u32 m0, s35, 0
    v_mfma_f32_32x32x16_bf16 v[192:207], a[52:55], v[0:3], 0
    ds_read_b128 a[44:47], v231 offset:32768
    buffer_load_dwordx4 v242, s[16:19], s10 offen lds
    v_exp_f32 v15, v15
    v_cvt_pk_bf16_f32 v6, v12, v13
    s_waitcnt lgkmcnt(5)
    v_mfma_f32_32x32x16_bf16 v[208:223], a[56:59], v[0:3], 0
    ds_read_b128 a[48:51], v230 offset:36864
    v_cvt_pk_bf16_f32 v7, v14, v15
    s_add_u32 m0, s35, 1024
    s_nop 0
    v_mfma_f32_32x32x16_bf16 v[192:207], a[60:63], v[4:7], v[192:207]
    ds_read_b128 a[52:55], v228 offset:49152
    buffer_load_dwordx4 v243, s[16:19], s10 offen lds
    v_exp_f32 v16, v16
    s_waitcnt vmcnt(22)
    s_barrier
    s_waitcnt lgkmcnt(4)
    v_mfma_f32_32x32x16_bf16 v[208:223], a[64:67], v[4:7], v[208:223]
    ds_read_b128 a[56:59], v231 offset:36864
    v_exp_f32 v17, v17
    v_exp_f32 v18, v18
    v_smfmac_f32_16x16x64_bf16 a[36:39], a[32:35], v[0:7], v249
    v_exp_f32 v19, v19
    v_cvt_pk_bf16_f32 v8, v16, v17
    s_add_u32 m0, s35, 65408
    v_mfma_f32_32x32x16_bf16 v[64:79], a[68:71], a[24:27], v[64:79]
    ds_read_b128 a[60:63], v229 offset:49152
    buffer_load_dwordx4 v242, s[16:19], s10 offen offset:128 lds
    v_exp_f32 v20, v20
    v_exp_f32 v21, v21
    s_waitcnt lgkmcnt(4)
    v_mfma_f32_32x32x16_bf16 v[80:95], a[40:43], a[20:23], v[80:95]
    ds_read_b64_tr_b16 a[64:65], v238 offset:45056
    ds_read_b64_tr_b16 a[66:67], v238 offset:46080
    v_cvt_pk_bf16_f32 v9, v18, v19
    v_exp_f32 v22, v22
    v_exp_f32 v23, v23
    s_add_u32 m0, s35, 66432
    v_mfma_f32_32x32x16_bf16 v[64:79], a[44:47], a[28:31], v[64:79]
    ds_read_b64_tr_b16 a[68:69], v239 offset:45056
    ds_read_b64_tr_b16 a[70:71], v239 offset:46080
    buffer_load_dwordx4 v243, s[16:19], s10 offen offset:128 lds
    v_cvt_pk_bf16_f32 v10, v20, v21
    v_exp_f32 v24, v24
    s_waitcnt lgkmcnt(6)
    v_mfma_f32_32x32x16_bf16 v[80:95], a[48:51], a[24:27], v[80:95]
    ds_read_b64_tr_b16 a[40:41], v238 offset:57344
    ds_read_b64_tr_b16 a[42:43], v238 offset:58368
    v_exp_f32 v25, v25
    v_cvt_pk_bf16_f32 v11, v22, v23
    v_exp_f32 v26, v26
    s_add_u32 m0, s35, 73728
    v_mfma_f32_32x32x16_bf16 v[96:111], a[52:55], a[16:19], v[96:111]
    ds_read_b64_tr_b16 a[44:45], v238 offset:47104
    ds_read_b64_tr_b16 a[46:47], v238 offset:48128
    buffer_load_dwordx4 v248, s[20:23], s9 offen lds
    v_exp_f32 v27, v27
    s_waitcnt lgkmcnt(8)
    v_mfma_f32_32x32x16_bf16 v[80:95], a[56:59], a[28:31], v[80:95]
    ds_read_b64_tr_b16 a[48:49], v238 offset:59392
    ds_read_b64_tr_b16 a[50:51], v238 offset:60416
    v_cvt_pk_bf16_f32 v12, v24, v25
    v_exp_f32 v28, v28
    v_exp_f32 v29, v29
    s_add_u32 m0, s35, 72704
    v_mfma_f32_32x32x16_bf16 v[96:111], a[60:63], a[20:23], v[96:111]
    ds_read_b64_tr_b16 a[52:53], v239 offset:47104
    ds_read_b64_tr_b16 a[54:55], v239 offset:48128
    buffer_load_dwordx4 v248, s[20:23], s9 offen offset:2048 lds
    v_cvt_pk_bf16_f32 v13, v26, v27
    v_exp_f32 v30, v30
    s_waitcnt lgkmcnt(8)
    v_mfma_f32_32x32x16_bf16 v[192:207], a[64:67], v[8:11], v[192:207]
    ds_read_b64_tr_b16 a[56:57], v238 offset:61440
    ds_read_b64_tr_b16 a[58:59], v238 offset:62464
    v_exp_f32 v31, v31
    v_cvt_pk_bf16_f32 v14, v28, v29
    v_cvt_pk_bf16_f32 v15, v30, v31
    s_add_u32 m0, s35, 81792
    v_mfma_f32_32x32x16_bf16 v[208:223], a[68:71], v[8:11], v[208:223]
    ds_read_b128 a[60:63], v230 offset:49152
    buffer_load_dwordx4 v248, s[20:23], s9 offen offset:128 lds
    s_waitcnt lgkmcnt(7)
    v_mfma_f32_32x32x16_bf16 v[16:31], a[40:43], v[0:3], 0
    ds_read_b64_tr_b16 a[64:65], v238 offset:63488
    ds_read_b64_tr_b16 a[66:67], v238 offset:64512
    v_exp_f32 v32, v32
    v_exp_f32 v33, v33
    s_add_u32 m0, s35, 80768
    v_mfma_f32_32x32x16_bf16 v[192:207], a[44:47], v[12:15], v[192:207]
    ds_read_b128 a[68:71], v231 offset:49152
    buffer_load_dwordx4 v248, s[20:23], s9 offen offset:2176 lds
    v_exp_f32 v34, v34
    v_smfmac_f32_16x16x64_bf16 a[36:39], a[32:35], v[8:15], v249
    v_exp_f32 v35, v35
    s_waitcnt vmcnt(20)
    s_barrier
    s_waitcnt lgkmcnt(6)
    v_mfma_f32_32x32x16_bf16 v[16:31], a[48:51], v[4:7], v[16:31]
    ds_read_b128 a[40:43], v228 offset:53248
    v_cvt_pk_bf16_f32 v32, v32, v33
    v_exp_f32 v36, v36
    v_exp_f32 v37, v37
    s_add_u32 m0, s35, 90112
    v_mfma_f32_32x32x16_bf16 v[208:223], a[52:55], v[12:15], v[208:223]
    ds_read_b64_tr_b16 a[44:45], v240 offset:0
    ds_read_b64_tr_b16 a[46:47], v240 offset:1024
    buffer_load_dwordx4 v242, s[16:19], s11 offen lds
    v_cvt_pk_bf16_f32 v33, v34, v35
    v_exp_f32 v38, v38
    s_waitcnt lgkmcnt(6)
    v_mfma_f32_32x32x16_bf16 v[16:31], a[56:59], v[8:11], v[16:31]
    ds_read_b64_tr_b16 a[48:49], v241 offset:0
    ds_read_b64_tr_b16 a[50:51], v241 offset:1024
    v_exp_f32 v39, v39
    v_cvt_pk_bf16_f32 v34, v36, v37
    v_exp_f32 v40, v40
    s_add_u32 m0, s35, 91136
    v_mfma_f32_32x32x16_bf16 v[96:111], a[60:63], a[24:27], v[96:111]
    ds_read_b64_tr_b16 a[52:53], v240 offset:8192
    ds_read_b64_tr_b16 a[54:55], v240 offset:9216
    buffer_load_dwordx4 v243, s[16:19], s11 offen lds
    v_exp_f32 v41, v41
    s_waitcnt lgkmcnt(7)
    v_mfma_f32_32x32x16_bf16 v[16:31], a[64:67], v[12:15], v[16:31]
    ds_read_b64_tr_b16 a[56:57], v240 offset:2048
    ds_read_b64_tr_b16 a[58:59], v240 offset:3072
    v_cvt_pk_bf16_f32 v35, v38, v39
    v_exp_f32 v42, v42
    v_exp_f32 v43, v43
    s_add_u32 m0, s35, 98176
    v_mfma_f32_32x32x16_bf16 v[96:111], a[68:71], a[28:31], v[96:111]
    ds_read_b64_tr_b16 a[60:61], v241 offset:2048
    ds_read_b64_tr_b16 a[62:63], v241 offset:3072
    buffer_load_dwordx4 v242, s[16:19], s11 offen offset:128 lds
    v_cvt_pk_bf16_f32 v36, v40, v41
    v_exp_f32 v44, v44
    s_waitcnt lgkmcnt(8)
    v_mfma_f32_32x32x16_bf16 v[112:127], a[40:43], a[16:19], v[112:127]
    ds_read_b64_tr_b16 a[64:65], v240 offset:10240
    ds_read_b64_tr_b16 a[66:67], v240 offset:11264
    v_exp_f32 v45, v45
    v_cvt_pk_bf16_f32 v37, v42, v43
    v_exp_f32 v46, v46
    s_add_u32 m0, s35, 99200
    v_mfma_f32_32x32x16_bf16 v[192:207], a[44:47], v[32:35], v[192:207]
    ds_read_b128 a[68:71], v229 offset:53248
    buffer_load_dwordx4 v243, s[16:19], s11 offen offset:128 lds
    v_exp_f32 v47, v47
    v_cvt_pk_bf16_f32 v38, v44, v45
    s_waitcnt lgkmcnt(7)
    v_mfma_f32_32x32x16_bf16 v[208:223], a[48:51], v[32:35], v[208:223]
    ds_read_b128 a[40:43], v232 offset:16384
    v_cvt_pk_bf16_f32 v39, v46, v47
    v_mfma_f32_32x32x16_bf16 v[16:31], a[52:55], v[32:35], v[16:31]
    ds_read_b128 a[44:47], v230 offset:53248
    v_exp_f32 v48, v48
    v_exp_f32 v49, v49
    s_waitcnt lgkmcnt(5)
    v_mfma_f32_32x32x16_bf16 v[192:207], a[56:59], v[36:39], v[192:207]
    ds_read_b128 a[48:51], v233 offset:16384
    v_exp_f32 v50, v50
    v_exp_f32 v51, v51
    v_smfmac_f32_16x16x64_bf16 a[36:39], a[32:35], v[32:39], v249
    v_cvt_pk_bf16_f32 v40, v48, v49
    v_exp_f32 v52, v52
    v_mfma_f32_32x32x16_bf16 v[208:223], a[60:63], v[36:39], v[208:223]
    ds_read_b128 a[52:55], v231 offset:53248
    v_exp_f32 v53, v53
    v_cvt_pk_bf16_f32 v41, v50, v51
    s_waitcnt vmcnt(18)
    s_barrier
    s_add_u32 m0, s35, 106496
    s_waitcnt lgkmcnt(4)
    v_mfma_f32_32x32x16_bf16 v[16:31], a[64:67], v[36:39], v[16:31]
    ds_read_b64_tr_b16 a[56:57], v240 offset:4096
    ds_read_b64_tr_b16 a[58:59], v240 offset:5120
    buffer_load_dwordx4 v248, s[20:23], s10 offen lds
    v_exp_f32 v54, v54
    v_mfma_f32_32x32x16_bf16 v[112:127], a[68:71], a[20:23], v[112:127]
    ds_read_b64_tr_b16 a[60:61], v241 offset:4096
    ds_read_b64_tr_b16 a[62:63], v241 offset:5120
    v_exp_f32 v55, v55
    v_cvt_pk_bf16_f32 v42, v52, v53
    s_add_u32 m0, s35, 105472
    s_waitcnt lgkmcnt(6)
    v_mfma_f32_32x32x16_bf16 v[128:143], a[40:43], a[16:19], v[128:143]
    ds_read_b64_tr_b16 a[64:65], v239 offset:57344
    ds_read_b64_tr_b16 a[66:67], v239 offset:58368
    buffer_load_dwordx4 v248, s[20:23], s10 offen offset:2048 lds
    v_exp_f32 v56, v56
    v_mfma_f32_32x32x16_bf16 v[112:127], a[44:47], a[24:27], v[112:127]
    ds_read_b64_tr_b16 a[68:69], v240 offset:12288
    ds_read_b64_tr_b16 a[70:71], v240 offset:13312
    v_exp_f32 v57, v57
    v_cvt_pk_bf16_f32 v43, v54, v55
    s_waitcnt lgkmcnt(8)
    v_mfma_f32_32x32x16_bf16 v[128:143], a[48:51], a[20:23], v[128:143]
    ds_read_b64_tr_b16 a[40:41], v239 offset:59392
    ds_read_b64_tr_b16 a[42:43], v239 offset:60416
    v_exp_f32 v58, v58
    v_exp_f32 v59, v59
    v_mfma_f32_32x32x16_bf16 v[112:127], a[52:55], a[28:31], v[112:127]
    ds_read_b64_tr_b16 a[44:45], v240 offset:6144
    ds_read_b64_tr_b16 a[46:47], v240 offset:7168
    v_cvt_pk_bf16_f32 v44, v56, v57
    v_exp_f32 v60, v60
    s_waitcnt lgkmcnt(8)
    v_mfma_f32_32x32x16_bf16 v[192:207], a[56:59], v[40:43], v[192:207]
    ds_read_b64_tr_b16 a[48:49], v239 offset:61440
    ds_read_b64_tr_b16 a[50:51], v239 offset:62464
    v_exp_f32 v61, v61
    v_cvt_pk_bf16_f32 v45, v58, v59
    v_exp_f32 v62, v62
    v_mfma_f32_32x32x16_bf16 v[208:223], a[60:63], v[40:43], v[208:223]
    ds_read_b64_tr_b16 a[52:53], v241 offset:6144
    ds_read_b64_tr_b16 a[54:55], v241 offset:7168
    v_exp_f32 v63, v63
    v_cvt_pk_bf16_f32 v46, v60, v61
    v_cvt_pk_bf16_f32 v47, v62, v63
    s_waitcnt lgkmcnt(8)
    v_mfma_f32_32x32x16_bf16 v[48:63], a[64:67], v[0:3], 0
    ds_read_b64_tr_b16 a[56:57], v239 offset:63488
    ds_read_b64_tr_b16 a[58:59], v239 offset:64512
    v_exp_f32 v64, v64
    v_exp_f32 v65, v65
    v_mfma_f32_32x32x16_bf16 v[16:31], a[68:71], v[40:43], v[16:31]
    ds_read_b64_tr_b16 a[60:61], v240 offset:14336
    ds_read_b64_tr_b16 a[62:63], v240 offset:15360
    v_exp_f32 v66, v66
    v_smfmac_f32_16x16x64_bf16 a[36:39], a[32:35], v[40:47], v249
    v_exp_f32 v67, v67
    v_cvt_pk_bf16_f32 v64, v64, v65
    s_waitcnt lgkmcnt(8)
    v_mfma_f32_32x32x16_bf16 v[48:63], a[40:43], v[4:7], v[48:63]
    ds_read_b64_tr_b16 a[64:65], v241 offset:8192
    ds_read_b64_tr_b16 a[66:67], v241 offset:9216
    v_exp_f32 v68, v68
    v_exp_f32 v69, v69
    v_cvt_pk_bf16_f32 v65, v66, v67
    v_mfma_f32_32x32x16_bf16 v[192:207], a[44:47], v[44:47], v[192:207]
    ds_read_b64_tr_b16 a[68:69], v236 offset:8192
    ds_read_b64_tr_b16 a[70:71], v236 offset:9216
    v_exp_f32 v70, v70
    s_waitcnt vmcnt(14)
    s_barrier
    s_add_u32 m0, s35, 114688
    s_waitcnt lgkmcnt(8)
    v_mfma_f32_32x32x16_bf16 v[48:63], a[48:51], v[8:11], v[48:63]
    ds_read_b64_tr_b16 a[40:41], v241 offset:10240
    ds_read_b64_tr_b16 a[42:43], v241 offset:11264
    buffer_load_dwordx4 v248, s[20:23], s11 offen lds
    v_exp_f32 v71, v71
    v_cvt_pk_bf16_f32 v66, v68, v69
    v_mfma_f32_32x32x16_bf16 v[208:223], a[52:55], v[44:47], v[208:223]
    ds_read_b64_tr_b16 a[44:45], v237 offset:8192
    ds_read_b64_tr_b16 a[46:47], v237 offset:9216
    v_exp_f32 v72, v72
    v_exp_f32 v73, v73
    s_add_u32 m0, s35, 113664
    s_waitcnt lgkmcnt(8)
    v_mfma_f32_32x32x16_bf16 v[48:63], a[56:59], v[12:15], v[48:63]
    ds_read_b64_tr_b16 a[48:49], v241 offset:12288
    ds_read_b64_tr_b16 a[50:51], v241 offset:13312
    buffer_load_dwordx4 v248, s[20:23], s11 offen offset:2048 lds
    v_cvt_pk_bf16_f32 v67, v70, v71
    v_exp_f32 v74, v74
    v_mfma_f32_32x32x16_bf16 v[16:31], a[60:63], v[44:47], v[16:31]
    ds_read_b64_tr_b16 a[52:53], v236 offset:32768
    ds_read_b64_tr_b16 a[54:55], v236 offset:33792
    v_exp_f32 v75, v75
    v_cvt_pk_bf16_f32 v68, v72, v73
    s_waitcnt lgkmcnt(8)
    v_mfma_f32_32x32x16_bf16 v[48:63], a[64:67], v[32:35], v[48:63]
    ds_read_b64_tr_b16 a[56:57], v241 offset:14336
    ds_read_b64_tr_b16 a[58:59], v241 offset:15360
    v_exp_f32 v76, v76
    v_exp_f32 v77, v77
    v_cvt_pk_bf16_f32 v69, v74, v75
    v_mfma_f32_32x32x16_bf16 v[192:207], a[68:71], v[64:67], v[192:207]
    ds_read_b64_tr_b16 a[60:61], v236 offset:10240
    ds_read_b64_tr_b16 a[62:63], v236 offset:11264
    v_exp_f32 v78, v78
    v_exp_f32 v79, v79
    s_waitcnt lgkmcnt(8)
    v_mfma_f32_32x32x16_bf16 v[48:63], a[40:43], v[36:39], v[48:63]
    ds_read_b64_tr_b16 a[64:65], v237 offset:32768
    ds_read_b64_tr_b16 a[66:67], v237 offset:33792
    v_cvt_pk_bf16_f32 v70, v76, v77
    v_cvt_pk_bf16_f32 v71, v78, v79
    v_mfma_f32_32x32x16_bf16 v[208:223], a[44:47], v[64:67], v[208:223]
    ds_read_b64_tr_b16 a[68:69], v237 offset:10240
    ds_read_b64_tr_b16 a[70:71], v237 offset:11264
    v_exp_f32 v80, v80
    v_exp_f32 v81, v81
    s_waitcnt lgkmcnt(8)
    v_mfma_f32_32x32x16_bf16 v[48:63], a[48:51], v[40:43], v[48:63]
    ds_read_b64_tr_b16 a[40:41], v236 offset:34816
    ds_read_b64_tr_b16 a[42:43], v236 offset:35840
    v_exp_f32 v82, v82
    v_exp_f32 v83, v83
    v_smfmac_f32_16x16x64_bf16 a[36:39], a[32:35], v[64:71], v249
    v_cvt_pk_bf16_f32 v72, v80, v81
    v_exp_f32 v84, v84
    v_mfma_f32_32x32x16_bf16 v[16:31], a[52:55], v[64:67], v[16:31]
    ds_read_b64_tr_b16 a[44:45], v237 offset:34816
    ds_read_b64_tr_b16 a[46:47], v237 offset:35840
    v_exp_f32 v85, v85
    v_cvt_pk_bf16_f32 v73, v82, v83
    s_waitcnt lgkmcnt(8)
    v_mfma_f32_32x32x16_bf16 v[48:63], a[56:59], v[44:47], v[48:63]
    ds_read_b64_tr_b16 a[48:49], v236 offset:12288
    ds_read_b64_tr_b16 a[50:51], v236 offset:13312
    v_exp_f32 v86, v86
    v_exp_f32 v87, v87
    v_cvt_pk_bf16_f32 v74, v84, v85
    v_mfma_f32_32x32x16_bf16 v[192:207], a[60:63], v[68:71], v[192:207]
    ds_read_b64_tr_b16 a[52:53], v237 offset:12288
    ds_read_b64_tr_b16 a[54:55], v237 offset:13312
    v_exp_f32 v88, v88
    s_waitcnt vmcnt(10)
    s_barrier
    s_add_u32 m0, s35, 122752
    s_waitcnt lgkmcnt(8)
    v_mfma_f32_32x32x16_bf16 v[48:63], a[64:67], v[64:67], v[48:63]
    ds_read_b64_tr_b16 a[56:57], v236 offset:36864
    ds_read_b64_tr_b16 a[58:59], v236 offset:37888
    buffer_load_dwordx4 v248, s[20:23], s10 offen offset:128 lds
    v_exp_f32 v89, v89
    v_cvt_pk_bf16_f32 v75, v86, v87
    v_mfma_f32_32x32x16_bf16 v[208:223], a[68:71], v[68:71], v[208:223]
    ds_read_b64_tr_b16 a[60:61], v237 offset:36864
    ds_read_b64_tr_b16 a[62:63], v237 offset:37888
    v_exp_f32 v90, v90
    v_exp_f32 v91, v91
    s_add_u32 m0, s35, 121728
    s_waitcnt lgkmcnt(8)
    v_mfma_f32_32x32x16_bf16 v[16:31], a[40:43], v[68:71], v[16:31]
    ds_read_b64_tr_b16 a[64:65], v236 offset:14336
    ds_read_b64_tr_b16 a[66:67], v236 offset:15360
    buffer_load_dwordx4 v248, s[20:23], s10 offen offset:2176 lds
    v_cvt_pk_bf16_f32 v76, v88, v89
    v_exp_f32 v92, v92
    v_mfma_f32_32x32x16_bf16 v[48:63], a[44:47], v[68:71], v[48:63]
    ds_read_b64_tr_b16 a[68:69], v237 offset:14336
    ds_read_b64_tr_b16 a[70:71], v237 offset:15360
    v_exp_f32 v93, v93
    v_cvt_pk_bf16_f32 v77, v90, v91
    s_add_u32 m0, s35, 130944
    s_waitcnt lgkmcnt(8)
    v_mfma_f32_32x32x16_bf16 v[192:207], a[48:51], v[72:75], v[192:207]
    ds_read_b64_tr_b16 a[40:41], v236 offset:38912
    ds_read_b64_tr_b16 a[42:43], v236 offset:39936
    buffer_load_dwordx4 v248, s[20:23], s11 offen offset:128 lds
    v_exp_f32 v94, v94
    v_exp_f32 v95, v95
    v_mfma_f32_32x32x16_bf16 v[208:223], a[52:55], v[72:75], v[208:223]
    ds_read_b64_tr_b16 a[44:45], v237 offset:38912
    ds_read_b64_tr_b16 a[46:47], v237 offset:39936
    v_cvt_pk_bf16_f32 v78, v92, v93
    v_cvt_pk_bf16_f32 v79, v94, v95
    s_add_u32 m0, s35, 129920
    s_waitcnt lgkmcnt(8)
    v_mfma_f32_32x32x16_bf16 v[16:31], a[56:59], v[72:75], v[16:31]
    ds_read_b128 a[48:51], v234 offset:16384
    buffer_load_dwordx4 v248, s[20:23], s11 offen offset:2176 lds
    v_exp_f32 v96, v96
    v_exp_f32 v97, v97
    v_mfma_f32_32x32x16_bf16 v[48:63], a[60:63], v[72:75], v[48:63]
    ds_read_b128 a[52:55], v232 offset:20480
    v_exp_f32 v98, v98
    v_exp_f32 v99, v99
    v_smfmac_f32_16x16x64_bf16 a[36:39], a[32:35], v[72:79], v249
    v_cvt_pk_bf16_f32 v96, v96, v97
    v_exp_f32 v100, v100
    s_waitcnt lgkmcnt(6)
    v_mfma_f32_32x32x16_bf16 v[192:207], a[64:67], v[76:79], v[192:207]
    ds_read_b128 a[56:59], v235 offset:16384
    v_exp_f32 v101, v101
    v_cvt_pk_bf16_f32 v97, v98, v99
    v_exp_f32 v102, v102
    v_mfma_f32_32x32x16_bf16 v[208:223], a[68:71], v[76:79], v[208:223]
    ds_read_b64_tr_b16 a[60:61], v236 offset:40960
    ds_read_b64_tr_b16 a[62:63], v236 offset:41984
    v_exp_f32 v103, v103
    v_cvt_pk_bf16_f32 v98, v100, v101
    s_waitcnt lgkmcnt(5)
    v_mfma_f32_32x32x16_bf16 v[16:31], a[40:43], v[76:79], v[16:31]
    ds_read_b64_tr_b16 a[64:65], v237 offset:40960
    ds_read_b64_tr_b16 a[66:67], v237 offset:41984
    v_exp_f32 v104, v104
    v_exp_f32 v105, v105
    v_mfma_f32_32x32x16_bf16 v[48:63], a[44:47], v[76:79], v[48:63]
    ds_read_b64_tr_b16 a[68:69], v236 offset:49152
    ds_read_b64_tr_b16 a[70:71], v236 offset:50176
    v_cvt_pk_bf16_f32 v99, v102, v103
    s_waitcnt vmcnt(8)
    s_barrier
    s_waitcnt lgkmcnt(7)
    v_mfma_f32_32x32x16_bf16 v[128:143], a[48:51], a[24:27], v[128:143]
    ds_read_b64_tr_b16 a[40:41], v237 offset:49152
    ds_read_b64_tr_b16 a[42:43], v237 offset:50176
    v_exp_f32 v106, v106
    v_exp_f32 v107, v107
    v_mfma_f32_32x32x16_bf16 v[144:159], a[52:55], a[16:19], v[144:159]
    ds_read_b64_tr_b16 a[44:45], v236 offset:43008
    ds_read_b64_tr_b16 a[46:47], v236 offset:44032
    v_cvt_pk_bf16_f32 v100, v104, v105
    v_exp_f32 v108, v108
    s_waitcnt lgkmcnt(8)
    v_mfma_f32_32x32x16_bf16 v[128:143], a[56:59], a[28:31], v[128:143]
    ds_read_b64_tr_b16 a[48:49], v237 offset:43008
    ds_read_b64_tr_b16 a[50:51], v237 offset:44032
    v_exp_f32 v109, v109
    v_cvt_pk_bf16_f32 v101, v106, v107
    v_mfma_f32_32x32x16_bf16 v[192:207], a[60:63], v[96:99], v[192:207]
    ds_read_b64_tr_b16 a[52:53], v236 offset:51200
    ds_read_b64_tr_b16 a[54:55], v236 offset:52224
    v_exp_f32 v110, v110
    v_exp_f32 v111, v111
    s_waitcnt lgkmcnt(8)
    v_mfma_f32_32x32x16_bf16 v[208:223], a[64:67], v[96:99], v[208:223]
    ds_read_b64_tr_b16 a[56:57], v237 offset:51200
    ds_read_b64_tr_b16 a[58:59], v237 offset:52224
    v_cvt_pk_bf16_f32 v102, v108, v109
    v_cvt_pk_bf16_f32 v103, v110, v111
    v_mfma_f32_32x32x16_bf16 v[16:31], a[68:71], v[96:99], v[16:31]
    ds_read_b128 a[60:63], v233 offset:20480
    v_exp_f32 v112, v112
    v_exp_f32 v113, v113
    s_waitcnt lgkmcnt(7)
    v_mfma_f32_32x32x16_bf16 v[48:63], a[40:43], v[96:99], v[48:63]
    ds_read_b128 a[64:67], v224 offset:57344
    v_exp_f32 v114, v114
    v_exp_f32 v115, v115
    v_smfmac_f32_16x16x64_bf16 a[36:39], a[32:35], v[96:103], v249
    v_cvt_pk_bf16_f32 v104, v112, v113
    v_exp_f32 v116, v116
    v_mfma_f32_32x32x16_bf16 v[192:207], a[44:47], v[100:103], v[192:207]
    ds_read_b128 a[68:71], v234 offset:20480
    v_exp_f32 v117, v117
    v_cvt_pk_bf16_f32 v105, v114, v115
    v_exp_f32 v118, v118
    s_waitcnt lgkmcnt(5)
    v_mfma_f32_32x32x16_bf16 v[208:223], a[48:51], v[100:103], v[208:223]
    ds_read_b64_tr_b16 a[40:41], v236 offset:45056
    ds_read_b64_tr_b16 a[42:43], v236 offset:46080
    v_exp_f32 v119, v119
    v_cvt_pk_bf16_f32 v106, v116, v117
    v_mfma_f32_32x32x16_bf16 v[16:31], a[52:55], v[100:103], v[16:31]
    ds_read_b64_tr_b16 a[44:45], v237 offset:45056
    ds_read_b64_tr_b16 a[46:47], v237 offset:46080
    v_exp_f32 v120, v120
    v_exp_f32 v121, v121
    s_waitcnt lgkmcnt(6)
    v_mfma_f32_32x32x16_bf16 v[48:63], a[56:59], v[100:103], v[48:63]
    ds_read_b64_tr_b16 a[48:49], v236 offset:53248
    ds_read_b64_tr_b16 a[50:51], v236 offset:54272
    v_cvt_pk_bf16_f32 v107, v118, v119
    v_exp_f32 v122, v122
    v_mfma_f32_32x32x16_bf16 v[144:159], a[60:63], a[20:23], v[144:159]
    ds_read_b64_tr_b16 a[52:53], v237 offset:53248
    ds_read_b64_tr_b16 a[54:55], v237 offset:54272
    v_exp_f32 v123, v123
    s_waitcnt vmcnt(6)
    s_barrier
    s_waitcnt lgkmcnt(8)
    v_mfma_f32_32x32x16_bf16 v[160:175], a[64:67], a[16:19], v[160:175]
    ds_read_b64_tr_b16 a[56:57], v236 offset:47104
    ds_read_b64_tr_b16 a[58:59], v236 offset:48128
    v_cvt_pk_bf16_f32 v108, v120, v121
    v_exp_f32 v124, v124
    v_mfma_f32_32x32x16_bf16 v[144:159], a[68:71], a[24:27], v[144:159]
    ds_read_b64_tr_b16 a[60:61], v237 offset:47104
    ds_read_b64_tr_b16 a[62:63], v237 offset:48128
    v_exp_f32 v125, v125
    v_cvt_pk_bf16_f32 v109, v122, v123
    s_waitcnt lgkmcnt(8)
    v_mfma_f32_32x32x16_bf16 v[192:207], a[40:43], v[104:107], v[192:207]
    ds_read_b64_tr_b16 a[64:65], v236 offset:55296
    ds_read_b64_tr_b16 a[66:67], v236 offset:56320
    v_exp_f32 v126, v126
    v_exp_f32 v127, v127
    v_mfma_f32_32x32x16_bf16 v[208:223], a[44:47], v[104:107], v[208:223]
    ds_read_b64_tr_b16 a[68:69], v237 offset:55296
    ds_read_b64_tr_b16 a[70:71], v237 offset:56320
    v_cvt_pk_bf16_f32 v110, v124, v125
    v_cvt_pk_bf16_f32 v111, v126, v127
    s_waitcnt lgkmcnt(8)
    v_mfma_f32_32x32x16_bf16 v[16:31], a[48:51], v[104:107], v[16:31]
    ds_read_b128 a[40:43], v235 offset:20480
    v_exp_f32 v128, v128
    v_exp_f32 v129, v129
    v_mfma_f32_32x32x16_bf16 v[48:63], a[52:55], v[104:107], v[48:63]
    ds_read_b128 a[44:47], v225 offset:57344
    v_exp_f32 v130, v130
    v_exp_f32 v131, v131
    v_smfmac_f32_16x16x64_bf16 a[36:39], a[32:35], v[104:111], v249
    v_cvt_pk_bf16_f32 v128, v128, v129
    v_exp_f32 v132, v132
    s_waitcnt lgkmcnt(6)
    v_mfma_f32_32x32x16_bf16 v[192:207], a[56:59], v[108:111], v[192:207]
    ds_read_b128 a[48:51], v224 offset:61440
    v_exp_f32 v133, v133
    v_cvt_pk_bf16_f32 v129, v130, v131
    v_exp_f32 v134, v134
    v_mfma_f32_32x32x16_bf16 v[208:223], a[60:63], v[108:111], v[208:223]
    ds_read_b64_tr_b16 a[52:53], v236 offset:16384
    ds_read_b64_tr_b16 a[54:55], v236 offset:17408
    v_exp_f32 v135, v135
    v_cvt_pk_bf16_f32 v130, v132, v133
    s_waitcnt lgkmcnt(5)
    v_mfma_f32_32x32x16_bf16 v[16:31], a[64:67], v[108:111], v[16:31]
    ds_read_b64_tr_b16 a[56:57], v237 offset:16384
    ds_read_b64_tr_b16 a[58:59], v237 offset:17408
    v_exp_f32 v136, v136
    v_exp_f32 v137, v137
    v_mfma_f32_32x32x16_bf16 v[48:63], a[68:71], v[108:111], v[48:63]
    ds_read_b64_tr_b16 a[60:61], v236 offset:24576
    ds_read_b64_tr_b16 a[62:63], v236 offset:25600
    v_cvt_pk_bf16_f32 v131, v134, v135
    v_exp_f32 v138, v138
    s_waitcnt lgkmcnt(7)
    v_mfma_f32_32x32x16_bf16 v[144:159], a[40:43], a[28:31], v[144:159]
    ds_read_b64_tr_b16 a[64:65], v237 offset:24576
    ds_read_b64_tr_b16 a[66:67], v237 offset:25600
    v_exp_f32 v139, v139
    v_cvt_pk_bf16_f32 v132, v136, v137
    v_mfma_f32_32x32x16_bf16 v[160:175], a[44:47], a[20:23], v[160:175]
    ds_read_b64_tr_b16 a[68:69], v236 offset:18432
    ds_read_b64_tr_b16 a[70:71], v236 offset:19456
    v_exp_f32 v140, v140
    s_waitcnt vmcnt(4)
    s_barrier
    s_waitcnt lgkmcnt(8)
    v_mfma_f32_32x32x16_bf16 v[176:191], a[48:51], a[16:19], v[176:191]
    ds_read_b64_tr_b16 a[40:41], v237 offset:18432
    ds_read_b64_tr_b16 a[42:43], v237 offset:19456
    v_exp_f32 v141, v141
    v_cvt_pk_bf16_f32 v133, v138, v139
    v_mfma_f32_32x32x16_bf16 v[192:207], a[52:55], v[128:131], v[192:207]
    ds_read_b64_tr_b16 a[44:45], v236 offset:26624
    ds_read_b64_tr_b16 a[46:47], v236 offset:27648
    v_exp_f32 v142, v142
    v_exp_f32 v143, v143
    s_waitcnt lgkmcnt(8)
    v_mfma_f32_32x32x16_bf16 v[208:223], a[56:59], v[128:131], v[208:223]
    ds_read_b64_tr_b16 a[48:49], v237 offset:26624
    ds_read_b64_tr_b16 a[50:51], v237 offset:27648
    v_cvt_pk_bf16_f32 v134, v140, v141
    v_cvt_pk_bf16_f32 v135, v142, v143
    v_mfma_f32_32x32x16_bf16 v[16:31], a[60:63], v[128:131], v[16:31]
    ds_read_b128 a[52:55], v226 offset:57344
    v_exp_f32 v144, v144
    v_exp_f32 v145, v145
    s_waitcnt lgkmcnt(7)
    v_mfma_f32_32x32x16_bf16 v[48:63], a[64:67], v[128:131], v[48:63]
    ds_read_b128 a[56:59], v225 offset:61440
    v_exp_f32 v146, v146
    v_exp_f32 v147, v147
    v_smfmac_f32_16x16x64_bf16 a[36:39], a[32:35], v[128:135], v249
    v_cvt_pk_bf16_f32 v136, v144, v145
    v_exp_f32 v148, v148
    v_mfma_f32_32x32x16_bf16 v[192:207], a[68:71], v[132:135], v[192:207]
    ds_read_b128 a[60:63], v227 offset:57344
    v_exp_f32 v149, v149
    v_cvt_pk_bf16_f32 v137, v146, v147
    v_exp_f32 v150, v150
    s_waitcnt lgkmcnt(5)
    v_mfma_f32_32x32x16_bf16 v[208:223], a[40:43], v[132:135], v[208:223]
    ds_read_b64_tr_b16 a[64:65], v236 offset:20480
    ds_read_b64_tr_b16 a[66:67], v236 offset:21504
    v_exp_f32 v151, v151
    v_cvt_pk_bf16_f32 v138, v148, v149
    v_mfma_f32_32x32x16_bf16 v[16:31], a[44:47], v[132:135], v[16:31]
    ds_read_b64_tr_b16 a[68:69], v237 offset:20480
    ds_read_b64_tr_b16 a[70:71], v237 offset:21504
    v_exp_f32 v152, v152
    v_exp_f32 v153, v153
    s_waitcnt lgkmcnt(6)
    v_mfma_f32_32x32x16_bf16 v[48:63], a[48:51], v[132:135], v[48:63]
    ds_read_b64_tr_b16 a[40:41], v236 offset:28672
    ds_read_b64_tr_b16 a[42:43], v236 offset:29696
    v_cvt_pk_bf16_f32 v139, v150, v151
    v_exp_f32 v154, v154
    v_mfma_f32_32x32x16_bf16 v[160:175], a[52:55], a[24:27], v[160:175]
    ds_read_b64_tr_b16 a[44:45], v237 offset:28672
    ds_read_b64_tr_b16 a[46:47], v237 offset:29696
    v_exp_f32 v155, v155
    v_cvt_pk_bf16_f32 v140, v152, v153
    s_waitcnt lgkmcnt(8)
    v_mfma_f32_32x32x16_bf16 v[176:191], a[56:59], a[20:23], v[176:191]
    ds_read_b64_tr_b16 a[48:49], v236 offset:22528
    ds_read_b64_tr_b16 a[50:51], v236 offset:23552
    v_exp_f32 v156, v156
    v_exp_f32 v157, v157
    v_mfma_f32_32x32x16_bf16 v[160:175], a[60:63], a[28:31], v[160:175]
    ds_read_b64_tr_b16 a[52:53], v237 offset:22528
    ds_read_b64_tr_b16 a[54:55], v237 offset:23552
    v_cvt_pk_bf16_f32 v141, v154, v155
    s_waitcnt vmcnt(0)
    s_barrier
    s_waitcnt lgkmcnt(8)
    v_mfma_f32_32x32x16_bf16 v[192:207], a[64:67], v[136:139], v[192:207]
    ds_read_b64_tr_b16 a[56:57], v236 offset:30720
    ds_read_b64_tr_b16 a[58:59], v236 offset:31744
    v_exp_f32 v158, v158
    v_exp_f32 v159, v159
    v_mfma_f32_32x32x16_bf16 v[208:223], a[68:71], v[136:139], v[208:223]
    ds_read_b64_tr_b16 a[60:61], v237 offset:30720
    ds_read_b64_tr_b16 a[62:63], v237 offset:31744
    v_cvt_pk_bf16_f32 v142, v156, v157
    v_cvt_pk_bf16_f32 v143, v158, v159
    s_waitcnt lgkmcnt(8)
    v_mfma_f32_32x32x16_bf16 v[16:31], a[40:43], v[136:139], v[16:31]
    ds_read_b128 a[64:67], v226 offset:61440
    v_exp_f32 v160, v160
    v_exp_f32 v161, v161
    v_mfma_f32_32x32x16_bf16 v[48:63], a[44:47], v[136:139], v[48:63]
    ds_read_b128 a[68:71], v224 offset:0
    v_exp_f32 v162, v162
    v_exp_f32 v163, v163
    v_smfmac_f32_16x16x64_bf16 a[36:39], a[32:35], v[136:143], v249
    v_cvt_pk_bf16_f32 v160, v160, v161
    s_waitcnt lgkmcnt(6)
    v_mfma_f32_32x32x16_bf16 v[192:207], a[48:51], v[140:143], v[192:207]
    ds_read_b128 a[40:43], v227 offset:61440
    v_exp_f32 v164, v164
    v_exp_f32 v165, v165
    v_mfma_f32_32x32x16_bf16 v[208:223], a[52:55], v[140:143], v[208:223]
    ds_read_b128 a[44:47], v225 offset:0
    v_cvt_pk_bf16_f32 v161, v162, v163
    v_exp_f32 v166, v166
    s_waitcnt lgkmcnt(4)
    v_mfma_f32_32x32x16_bf16 v[16:31], a[56:59], v[140:143], v[16:31]
    ds_read_b128 a[48:51], v224 offset:4096
    v_exp_f32 v167, v167
    v_cvt_pk_bf16_f32 v162, v164, v165
    v_mfma_f32_32x32x16_bf16 v[48:63], a[60:63], v[140:143], v[48:63]
    ds_read_b128 a[52:55], v226 offset:0
    v_exp_f32 v168, v168
    v_exp_f32 v169, v169
    s_waitcnt lgkmcnt(4)
    v_mfma_f32_32x32x16_bf16 v[176:191], a[64:67], a[24:27], v[176:191]
    ds_read_b128 a[56:59], v225 offset:4096
    v_cvt_pk_bf16_f32 v163, v166, v167
    v_exp_f32 v170, v170
    v_mfma_f32_32x32x16_bf16 v[80:95], a[68:71], a[0:3], 0
    ds_read_b128 a[60:63], v227 offset:0
    v_exp_f32 v171, v171
    v_cvt_pk_bf16_f32 v164, v168, v169
    s_waitcnt lgkmcnt(4)
    v_mfma_f32_32x32x16_bf16 v[176:191], a[40:43], a[28:31], v[176:191]
    ds_read_b128 a[64:67], v226 offset:4096
    v_exp_f32 v172, v172
    v_exp_f32 v173, v173
    v_mfma_f32_32x32x16_bf16 v[80:95], a[44:47], a[4:7], v[80:95]
    ds_read_b128 a[68:71], v228 offset:0
    v_cvt_pk_bf16_f32 v165, v170, v171
    v_exp_f32 v174, v174
    s_waitcnt lgkmcnt(4)
    v_mfma_f32_32x32x16_bf16 v[112:127], a[48:51], a[0:3], 0
    ds_read_b128 a[40:43], v227 offset:4096
    v_exp_f32 v175, v175
    v_cvt_pk_bf16_f32 v166, v172, v173
    v_cvt_pk_bf16_f32 v167, v174, v175
    v_mfma_f32_32x32x16_bf16 v[80:95], a[52:55], a[8:11], v[80:95]
    ds_read_b128 a[44:47], v229 offset:0
    v_exp_f32 v176, v176
    v_exp_f32 v177, v177
    s_waitcnt lgkmcnt(4)
    v_mfma_f32_32x32x16_bf16 v[112:127], a[56:59], a[4:7], v[112:127]
    ds_read_b128 a[48:51], v228 offset:4096
    v_exp_f32 v178, v178
    v_exp_f32 v179, v179
    v_smfmac_f32_16x16x64_bf16 a[36:39], a[32:35], v[160:167], v249
    v_cvt_pk_bf16_f32 v168, v176, v177
    v_exp_f32 v180, v180
    v_mfma_f32_32x32x16_bf16 v[80:95], a[60:63], a[12:15], v[80:95]
    ds_read_b128 a[52:55], v230 offset:0
    v_exp_f32 v181, v181
    v_cvt_pk_bf16_f32 v169, v178, v179
    s_waitcnt lgkmcnt(4)
    v_mfma_f32_32x32x16_bf16 v[112:127], a[64:67], a[8:11], v[112:127]
    ds_read_b128 a[56:59], v229 offset:4096
    v_exp_f32 v182, v182
    v_exp_f32 v183, v183
    v_cvt_pk_bf16_f32 v170, v180, v181
    v_mfma_f32_32x32x16_bf16 v[80:95], a[68:71], a[16:19], v[80:95]
    ds_read_b128 a[60:63], v231 offset:0
    v_exp_f32 v184, v184
    v_exp_f32 v185, v185
    s_waitcnt lgkmcnt(4)
    v_mfma_f32_32x32x16_bf16 v[112:127], a[40:43], a[12:15], v[112:127]
    ds_read_b64_tr_b16 a[64:65], v238 offset:8192
    ds_read_b64_tr_b16 a[66:67], v238 offset:9216
    v_cvt_pk_bf16_f32 v171, v182, v183
    v_exp_f32 v186, v186
    v_mfma_f32_32x32x16_bf16 v[80:95], a[44:47], a[20:23], v[80:95]
    ds_read_b64_tr_b16 a[68:69], v239 offset:8192
    ds_read_b64_tr_b16 a[70:71], v239 offset:9216
    v_exp_f32 v187, v187
    v_cvt_pk_bf16_f32 v172, v184, v185
    s_waitcnt lgkmcnt(6)
    v_mfma_f32_32x32x16_bf16 v[112:127], a[48:51], a[16:19], v[112:127]
    ds_read_b64_tr_b16 a[40:41], v238 offset:16384
    ds_read_b64_tr_b16 a[42:43], v238 offset:17408
    v_exp_f32 v188, v188
    v_exp_f32 v189, v189
    v_mfma_f32_32x32x16_bf16 v[80:95], a[52:55], a[24:27], v[80:95]
    ds_read_b64_tr_b16 a[44:45], v239 offset:16384
    ds_read_b64_tr_b16 a[46:47], v239 offset:17408
    v_cvt_pk_bf16_f32 v173, v186, v187
    v_exp_f32 v190, v190
    s_waitcnt lgkmcnt(8)
    v_mfma_f32_32x32x16_bf16 v[112:127], a[56:59], a[20:23], v[112:127]
    ds_read_b64_tr_b16 a[48:49], v238 offset:10240
    ds_read_b64_tr_b16 a[50:51], v238 offset:11264
    v_exp_f32 v191, v191
    v_cvt_pk_bf16_f32 v174, v188, v189
    v_cvt_pk_bf16_f32 v175, v190, v191
    v_mfma_f32_32x32x16_bf16 v[80:95], a[60:63], a[28:31], v[80:95]
    ds_read_b64_tr_b16 a[52:53], v239 offset:10240
    ds_read_b64_tr_b16 a[54:55], v239 offset:11264
    s_waitcnt lgkmcnt(8)
    v_mfma_f32_32x32x16_bf16 v[192:207], a[64:67], v[160:163], v[192:207]
    ds_read_b128 a[56:59], v230 offset:4096
    s_nop 6
    v_exp_f32 v80, v80
    v_exp_f32 v81, v81
    v_mfma_f32_32x32x16_bf16 v[208:223], a[68:71], v[160:163], v[208:223]
    ds_read_b128 a[60:63], v228 offset:24576
    v_exp_f32 v82, v82
    v_exp_f32 v83, v83
    v_smfmac_f32_16x16x64_bf16 a[36:39], a[32:35], v[168:175], v249
    v_cvt_pk_bf16_f32 v80, v80, v81
    s_waitcnt lgkmcnt(6)
    v_mfma_f32_32x32x16_bf16 v[16:31], a[40:43], v[160:163], v[16:31]
    ds_read_b128 a[64:67], v231 offset:4096
    v_exp_f32 v84, v84
    v_exp_f32 v85, v85
    v_mfma_f32_32x32x16_bf16 v[48:63], a[44:47], v[160:163], v[48:63]
    ds_read_b128 a[68:71], v229 offset:24576
    v_cvt_pk_bf16_f32 v81, v82, v83
    v_exp_f32 v86, v86
    s_waitcnt lgkmcnt(4)
    v_mfma_f32_32x32x16_bf16 v[192:207], a[48:51], v[164:167], v[192:207]
    ds_read_b128 a[40:43], v228 offset:28672
    v_exp_f32 v87, v87
    v_cvt_pk_bf16_f32 v82, v84, v85
    v_mfma_f32_32x32x16_bf16 v[208:223], a[52:55], v[164:167], v[208:223]
    ds_read_b128 a[44:47], v230 offset:24576
    v_exp_f32 v88, v88
    v_exp_f32 v89, v89
    s_waitcnt lgkmcnt(4)
    v_mfma_f32_32x32x16_bf16 v[112:127], a[56:59], a[24:27], v[112:127]
    ds_read_b128 a[48:51], v229 offset:28672
    v_cvt_pk_bf16_f32 v83, v86, v87
    v_exp_f32 v90, v90
    v_mfma_f32_32x32x16_bf16 v[144:159], a[60:63], a[0:3], 0
    ds_read_b128 a[52:55], v231 offset:24576
    v_exp_f32 v91, v91
    v_cvt_pk_bf16_f32 v84, v88, v89
    s_waitcnt lgkmcnt(4)
    v_mfma_f32_32x32x16_bf16 v[112:127], a[64:67], a[28:31], v[112:127]
    ds_read_b128 a[56:59], v230 offset:28672
    v_exp_f32 v92, v92
    v_exp_f32 v93, v93
    v_mfma_f32_32x32x16_bf16 v[144:159], a[68:71], a[4:7], v[144:159]
    ds_read_b128 a[60:63], v228 offset:32768
    v_cvt_pk_bf16_f32 v85, v90, v91
    v_exp_f32 v94, v94
    s_waitcnt lgkmcnt(4)
    v_mfma_f32_32x32x16_bf16 v[176:191], a[40:43], a[0:3], 0
    ds_read_b128 a[64:67], v231 offset:28672
    v_exp_f32 v95, v95
    v_cvt_pk_bf16_f32 v86, v92, v93
    v_cvt_pk_bf16_f32 v87, v94, v95
    v_mfma_f32_32x32x16_bf16 v[144:159], a[44:47], a[8:11], v[144:159]
    ds_read_b128 a[68:71], v229 offset:32768
    v_exp_f32 v112, v112
    v_exp_f32 v113, v113
    s_waitcnt lgkmcnt(4)
    v_mfma_f32_32x32x16_bf16 v[176:191], a[48:51], a[4:7], v[176:191]
    ds_read_b128 a[40:43], v228 offset:36864
    v_exp_f32 v114, v114
    v_exp_f32 v115, v115
    v_smfmac_f32_16x16x64_bf16 a[36:39], a[32:35], v[80:87], v249
    v_cvt_pk_bf16_f32 v88, v112, v113
    v_exp_f32 v116, v116
    v_mfma_f32_32x32x16_bf16 v[144:159], a[52:55], a[12:15], v[144:159]
    ds_read_b128 a[44:47], v230 offset:32768
    v_exp_f32 v117, v117
    v_cvt_pk_bf16_f32 v89, v114, v115
    s_waitcnt lgkmcnt(4)
    v_mfma_f32_32x32x16_bf16 v[176:191], a[56:59], a[8:11], v[176:191]
    ds_read_b128 a[48:51], v229 offset:36864
    v_exp_f32 v118, v118
    v_exp_f32 v119, v119
    v_cvt_pk_bf16_f32 v90, v116, v117
    v_mfma_f32_32x32x16_bf16 v[144:159], a[60:63], a[16:19], v[144:159]
    ds_read_b128 a[52:55], v231 offset:32768
    v_exp_f32 v120, v120
    v_exp_f32 v121, v121
    s_waitcnt lgkmcnt(4)
    v_mfma_f32_32x32x16_bf16 v[176:191], a[64:67], a[12:15], v[176:191]
    ds_read_b64_tr_b16 a[56:57], v238 offset:18432
    ds_read_b64_tr_b16 a[58:59], v238 offset:19456
    v_cvt_pk_bf16_f32 v91, v118, v119
    v_exp_f32 v122, v122
    v_mfma_f32_32x32x16_bf16 v[144:159], a[68:71], a[20:23], v[144:159]
    ds_read_b64_tr_b16 a[60:61], v239 offset:18432
    ds_read_b64_tr_b16 a[62:63], v239 offset:19456
    v_exp_f32 v123, v123
    v_cvt_pk_bf16_f32 v92, v120, v121
    s_waitcnt lgkmcnt(6)
    v_mfma_f32_32x32x16_bf16 v[176:191], a[40:43], a[16:19], v[176:191]
    ds_read_b64_tr_b16 a[64:65], v238 offset:12288
    ds_read_b64_tr_b16 a[66:67], v238 offset:13312
    v_exp_f32 v124, v124
    v_exp_f32 v125, v125
    v_mfma_f32_32x32x16_bf16 v[144:159], a[44:47], a[24:27], v[144:159]
    ds_read_b64_tr_b16 a[68:69], v239 offset:12288
    ds_read_b64_tr_b16 a[70:71], v239 offset:13312
    v_cvt_pk_bf16_f32 v93, v122, v123
    v_exp_f32 v126, v126
    s_waitcnt lgkmcnt(8)
    v_mfma_f32_32x32x16_bf16 v[176:191], a[48:51], a[20:23], v[176:191]
    ds_read_b64_tr_b16 a[40:41], v238 offset:14336
    ds_read_b64_tr_b16 a[42:43], v238 offset:15360
    v_exp_f32 v127, v127
    v_cvt_pk_bf16_f32 v94, v124, v125
    v_cvt_pk_bf16_f32 v95, v126, v127
    v_mfma_f32_32x32x16_bf16 v[144:159], a[52:55], a[28:31], v[144:159]
    ds_read_b64_tr_b16 a[44:45], v239 offset:14336
    ds_read_b64_tr_b16 a[46:47], v239 offset:15360
    s_waitcnt lgkmcnt(8)
    v_mfma_f32_32x32x16_bf16 v[16:31], a[56:59], v[164:167], v[16:31]
    ds_read_b64_tr_b16 a[48:49], v238 offset:40960
    ds_read_b64_tr_b16 a[50:51], v238 offset:41984
    s_nop 5
    v_exp_f32 v144, v144
    v_exp_f32 v145, v145
    v_mfma_f32_32x32x16_bf16 v[48:63], a[60:63], v[164:167], v[48:63]
    ds_read_b128 a[52:55], v230 offset:36864
    v_exp_f32 v146, v146
    v_exp_f32 v147, v147
    v_smfmac_f32_16x16x64_bf16 a[36:39], a[32:35], v[88:95], v249
    v_cvt_pk_bf16_f32 v144, v144, v145
    v_exp_f32 v148, v148
    s_waitcnt lgkmcnt(7)
    v_mfma_f32_32x32x16_bf16 v[192:207], a[64:67], v[168:171], v[192:207]
    ds_read_b64_tr_b16 a[56:57], v239 offset:40960
    ds_read_b64_tr_b16 a[58:59], v239 offset:41984
    v_exp_f32 v149, v149
    v_cvt_pk_bf16_f32 v145, v146, v147
    v_mfma_f32_32x32x16_bf16 v[208:223], a[68:71], v[168:171], v[208:223]
    ds_read_b128 a[60:63], v231 offset:36864
    v_exp_f32 v150, v150
    v_exp_f32 v151, v151
    s_waitcnt lgkmcnt(6)
    v_mfma_f32_32x32x16_bf16 v[192:207], a[40:43], v[172:175], v[192:207]
    ds_read_b64_tr_b16 a[64:65], v238 offset:43008
    ds_read_b64_tr_b16 a[66:67], v238 offset:44032
    v_cvt_pk_bf16_f32 v146, v148, v149
    v_exp_f32 v152, v152
    v_mfma_f32_32x32x16_bf16 v[208:223], a[44:47], v[172:175], v[208:223]
    ds_read_b64_tr_b16 a[68:69], v239 offset:43008
    ds_read_b64_tr_b16 a[70:71], v239 offset:44032
    v_exp_f32 v153, v153
    v_cvt_pk_bf16_f32 v147, v150, v151
    s_waitcnt lgkmcnt(7)
    v_mfma_f32_32x32x16_bf16 v[192:207], a[48:51], v[80:83], v[192:207]
    ds_read_b64_tr_b16 a[40:41], v238 offset:45056
    ds_read_b64_tr_b16 a[42:43], v238 offset:46080
    v_exp_f32 v154, v154
    v_exp_f32 v155, v155
    v_mfma_f32_32x32x16_bf16 v[176:191], a[52:55], a[24:27], v[176:191]
    ds_read_b64_tr_b16 a[44:45], v239 offset:45056
    ds_read_b64_tr_b16 a[46:47], v239 offset:46080
    v_cvt_pk_bf16_f32 v148, v152, v153
    v_exp_f32 v156, v156
    s_waitcnt lgkmcnt(8)
    v_mfma_f32_32x32x16_bf16 v[208:223], a[56:59], v[80:83], v[208:223]
    ds_read_b64_tr_b16 a[48:49], v238 offset:47104
    ds_read_b64_tr_b16 a[50:51], v238 offset:48128
    v_exp_f32 v157, v157
    v_cvt_pk_bf16_f32 v149, v154, v155
    v_mfma_f32_32x32x16_bf16 v[176:191], a[60:63], a[28:31], v[176:191]
    ds_read_b64_tr_b16 a[52:53], v239 offset:47104
    ds_read_b64_tr_b16 a[54:55], v239 offset:48128
    v_exp_f32 v158, v158
    v_exp_f32 v159, v159
    s_waitcnt lgkmcnt(8)
    v_mfma_f32_32x32x16_bf16 v[192:207], a[64:67], v[84:87], v[192:207]
    ds_read_b64_tr_b16 a[56:57], v238 offset:49152
    ds_read_b64_tr_b16 a[58:59], v238 offset:50176
    v_cvt_pk_bf16_f32 v150, v156, v157
    v_cvt_pk_bf16_f32 v151, v158, v159
    v_mfma_f32_32x32x16_bf16 v[208:223], a[68:71], v[84:87], v[208:223]
    ds_read_b64_tr_b16 a[60:61], v239 offset:49152
    ds_read_b64_tr_b16 a[62:63], v239 offset:50176
    v_exp_f32 v176, v176
    v_exp_f32 v177, v177
    s_waitcnt lgkmcnt(8)
    v_mfma_f32_32x32x16_bf16 v[192:207], a[40:43], v[88:91], v[192:207]
    ds_read_b64_tr_b16 a[64:65], v238 offset:51200
    ds_read_b64_tr_b16 a[66:67], v238 offset:52224
    v_exp_f32 v178, v178
    v_exp_f32 v179, v179
    v_smfmac_f32_16x16x64_bf16 a[36:39], a[32:35], v[144:151], v249
    v_cvt_pk_bf16_f32 v152, v176, v177
    v_exp_f32 v180, v180
    v_mfma_f32_32x32x16_bf16 v[208:223], a[44:47], v[88:91], v[208:223]
    ds_read_b64_tr_b16 a[68:69], v239 offset:51200
    ds_read_b64_tr_b16 a[70:71], v239 offset:52224
    v_exp_f32 v181, v181
    v_cvt_pk_bf16_f32 v153, v178, v179
    s_waitcnt lgkmcnt(8)
    v_mfma_f32_32x32x16_bf16 v[192:207], a[48:51], v[92:95], v[192:207]
    ds_read_b64_tr_b16 a[40:41], v238 offset:53248
    ds_read_b64_tr_b16 a[42:43], v238 offset:54272
    v_exp_f32 v182, v182
    v_exp_f32 v183, v183
    v_mfma_f32_32x32x16_bf16 v[208:223], a[52:55], v[92:95], v[208:223]
    ds_read_b64_tr_b16 a[44:45], v239 offset:53248
    ds_read_b64_tr_b16 a[46:47], v239 offset:54272
    v_cvt_pk_bf16_f32 v154, v180, v181
    v_exp_f32 v184, v184
    s_waitcnt lgkmcnt(8)
    v_mfma_f32_32x32x16_bf16 v[192:207], a[56:59], v[144:147], v[192:207]
    ds_read_b64_tr_b16 a[48:49], v238 offset:55296
    ds_read_b64_tr_b16 a[50:51], v238 offset:56320
    v_exp_f32 v185, v185
    v_cvt_pk_bf16_f32 v155, v182, v183
    v_exp_f32 v186, v186
    v_mfma_f32_32x32x16_bf16 v[208:223], a[60:63], v[144:147], v[208:223]
    ds_read_b64_tr_b16 a[52:53], v239 offset:55296
    ds_read_b64_tr_b16 a[54:55], v239 offset:56320
    v_exp_f32 v187, v187
    v_cvt_pk_bf16_f32 v156, v184, v185
    s_waitcnt lgkmcnt(8)
    v_mfma_f32_32x32x16_bf16 v[192:207], a[64:67], v[148:151], v[192:207]
    ds_read_b64_tr_b16 a[56:57], v238 offset:20480
    ds_read_b64_tr_b16 a[58:59], v238 offset:21504
    v_exp_f32 v188, v188
    v_exp_f32 v189, v189
    v_mfma_f32_32x32x16_bf16 v[208:223], a[68:71], v[148:151], v[208:223]
    ds_read_b64_tr_b16 a[60:61], v239 offset:20480
    ds_read_b64_tr_b16 a[62:63], v239 offset:21504
    v_cvt_pk_bf16_f32 v157, v186, v187
    v_exp_f32 v190, v190
    s_waitcnt lgkmcnt(8)
    v_mfma_f32_32x32x16_bf16 v[192:207], a[40:43], v[152:155], v[192:207]
    ds_read_b64_tr_b16 a[64:65], v238 offset:22528
    ds_read_b64_tr_b16 a[66:67], v238 offset:23552
    v_exp_f32 v191, v191
    v_cvt_pk_bf16_f32 v158, v188, v189
    v_cvt_pk_bf16_f32 v159, v190, v191
    v_mfma_f32_32x32x16_bf16 v[208:223], a[44:47], v[152:155], v[208:223]
    ds_read_b64_tr_b16 a[68:69], v239 offset:22528
    ds_read_b64_tr_b16 a[70:71], v239 offset:23552
    s_waitcnt lgkmcnt(8)
    v_mfma_f32_32x32x16_bf16 v[192:207], a[48:51], v[156:159], v[192:207]
    ds_read_b64_tr_b16 a[40:41], v238 offset:57344
    ds_read_b64_tr_b16 a[42:43], v238 offset:58368
    v_smfmac_f32_16x16x64_bf16 a[36:39], a[32:35], v[152:159], v249
    v_mfma_f32_32x32x16_bf16 v[208:223], a[52:55], v[156:159], v[208:223]
    ds_read_b64_tr_b16 a[44:45], v239 offset:57344
    ds_read_b64_tr_b16 a[46:47], v239 offset:58368
    s_nop 7
    s_nop 0
    v_accvgpr_read_b32 v244, a36
    v_accvgpr_read_b32 v246, a37
    v_add_f32 v244, v244, v246
    v_rcp_f32 v252, v244
    v_subrev_u32 v246, 0x21800000, v244
    v_cmp_lt_u32 vcc, 0x3c000000, v246
    s_cmp_lg_u64 vcc, 0
    s_cselect_b32 s36, 1, 0
    s_lshl_b32 s28, s34, 2
    s_add_u32 s28, s28, 155648
    v_mov_b32 v246, s36
    v_mov_b32 v245, s28
    ds_write_b32 v245, v246
    s_waitcnt lgkmcnt(9)
    v_mfma_f32_32x32x16_bf16 v[16:31], a[56:59], v[168:171], v[16:31]
    ds_read_b64_tr_b16 a[48:49], v238 offset:59392
    ds_read_b64_tr_b16 a[50:51], v238 offset:60416
    v_mul_f32 v192, v252, v192
    v_mul_f32 v193, v252, v193
    v_mul_f32 v194, v252, v194
    v_mul_f32 v195, v252, v195
    v_mul_f32 v196, v252, v196
    v_mfma_f32_32x32x16_bf16 v[48:63], a[60:63], v[168:171], v[48:63]
    ds_read_b64_tr_b16 a[52:53], v239 offset:59392
    ds_read_b64_tr_b16 a[54:55], v239 offset:60416
    v_mul_f32 v197, v252, v197
    v_mul_f32 v198, v252, v198
    v_mul_f32 v199, v252, v199
    v_cvt_pk_bf16_f32 v176, v192, v193
    v_cvt_pk_bf16_f32 v177, v194, v195
    s_waitcnt lgkmcnt(9)
    v_mfma_f32_32x32x16_bf16 v[16:31], a[64:67], v[172:175], v[16:31]
    ds_read_b64_tr_b16 a[56:57], v238 offset:61440
    ds_read_b64_tr_b16 a[58:59], v238 offset:62464
    v_cvt_pk_bf16_f32 v178, v196, v197
    v_cvt_pk_bf16_f32 v179, v198, v199
    ds_write_b128 v254, v[176:179]
    v_mul_f32 v200, v252, v200
    v_mul_f32 v201, v252, v201
    v_mfma_f32_32x32x16_bf16 v[48:63], a[68:71], v[172:175], v[48:63]
    ds_read_b64_tr_b16 a[60:61], v239 offset:61440
    ds_read_b64_tr_b16 a[62:63], v239 offset:62464
    v_mul_f32 v202, v252, v202
    v_mul_f32 v203, v252, v203
    v_mul_f32 v204, v252, v204
    v_mul_f32 v205, v252, v205
    v_mul_f32 v206, v252, v206
    s_waitcnt lgkmcnt(10)
    v_mfma_f32_32x32x16_bf16 v[16:31], a[40:43], v[80:83], v[16:31]
    ds_read_b64_tr_b16 a[64:65], v238 offset:63488
    ds_read_b64_tr_b16 a[66:67], v238 offset:64512
    v_mul_f32 v207, v252, v207
    v_cvt_pk_bf16_f32 v180, v200, v201
    v_cvt_pk_bf16_f32 v181, v202, v203
    v_cvt_pk_bf16_f32 v182, v204, v205
    v_cvt_pk_bf16_f32 v183, v206, v207
    v_mfma_f32_32x32x16_bf16 v[48:63], a[44:47], v[80:83], v[48:63]
    ds_read_b64_tr_b16 a[68:69], v239 offset:63488
    ds_read_b64_tr_b16 a[70:71], v239 offset:64512
    v_xor_b32 v245, 16, v254
    ds_write_b128 v245, v[180:183]
    ds_read_b128 v[176:179], v255 offset:0
    ds_read_b128 v[180:183], v255 offset:1024
    s_waitcnt lgkmcnt(12)
    v_mfma_f32_32x32x16_bf16 v[16:31], a[48:51], v[84:87], v[16:31]
    ds_read_b64_tr_b16 a[40:41], v240 offset:0
    ds_read_b64_tr_b16 a[42:43], v240 offset:1024
    v_mul_f32 v208, v252, v208
    v_mul_f32 v209, v252, v209
    v_mul_f32 v210, v252, v210
    v_mul_f32 v211, v252, v211
    v_mul_f32 v212, v252, v212
    v_mfma_f32_32x32x16_bf16 v[48:63], a[52:55], v[84:87], v[48:63]
    ds_read_b64_tr_b16 a[44:45], v241 offset:0
    ds_read_b64_tr_b16 a[46:47], v241 offset:1024
    s_waitcnt lgkmcnt(5)
    buffer_store_dwordx4 v[176:179], v251, s[24:27], s32 offen offset:0 sc1
    v_mul_f32 v213, v252, v213
    v_mul_f32 v214, v252, v214
    v_mul_f32 v215, v252, v215
    v_cvt_pk_bf16_f32 v184, v208, v209
    v_cvt_pk_bf16_f32 v185, v210, v211
    v_mfma_f32_32x32x16_bf16 v[16:31], a[56:59], v[88:91], v[16:31]
    ds_read_b64_tr_b16 a[48:49], v240 offset:2048
    ds_read_b64_tr_b16 a[50:51], v240 offset:3072
    s_waitcnt lgkmcnt(6)
    buffer_store_dwordx4 v[180:183], v251, s[24:27], s42 offen offset:0 sc1
    v_cvt_pk_bf16_f32 v186, v212, v213
    v_cvt_pk_bf16_f32 v187, v214, v215
    ds_write_b128 v254, v[184:187]
    v_mul_f32 v216, v252, v216
    v_mul_f32 v217, v252, v217
    v_mfma_f32_32x32x16_bf16 v[48:63], a[60:63], v[88:91], v[48:63]
    ds_read_b64_tr_b16 a[52:53], v241 offset:2048
    ds_read_b64_tr_b16 a[54:55], v241 offset:3072
    v_mul_f32 v218, v252, v218
    v_mul_f32 v219, v252, v219
    v_mul_f32 v220, v252, v220
    v_mul_f32 v221, v252, v221
    v_mul_f32 v222, v252, v222
    v_mfma_f32_32x32x16_bf16 v[16:31], a[64:67], v[92:95], v[16:31]
    ds_read_b64_tr_b16 a[56:57], v240 offset:4096
    ds_read_b64_tr_b16 a[58:59], v240 offset:5120
    v_mul_f32 v223, v252, v223
    v_cvt_pk_bf16_f32 v188, v216, v217
    v_cvt_pk_bf16_f32 v189, v218, v219
    v_cvt_pk_bf16_f32 v190, v220, v221
    v_cvt_pk_bf16_f32 v191, v222, v223
    v_mfma_f32_32x32x16_bf16 v[48:63], a[68:71], v[92:95], v[48:63]
    ds_read_b64_tr_b16 a[60:61], v241 offset:4096
    ds_read_b64_tr_b16 a[62:63], v241 offset:5120
    v_xor_b32 v245, 16, v254
    ds_write_b128 v245, v[188:191]
    ds_read_b128 v[184:187], v255 offset:0
    ds_read_b128 v[188:191], v255 offset:1024
    s_waitcnt lgkmcnt(12)
    v_mfma_f32_32x32x16_bf16 v[16:31], a[40:43], v[144:147], v[16:31]
    ds_read_b64_tr_b16 a[64:65], v240 offset:6144
    ds_read_b64_tr_b16 a[66:67], v240 offset:7168
    v_mfma_f32_32x32x16_bf16 v[48:63], a[44:47], v[144:147], v[48:63]
    ds_read_b64_tr_b16 a[68:69], v241 offset:6144
    ds_read_b64_tr_b16 a[70:71], v241 offset:7168
    s_waitcnt lgkmcnt(5)
    buffer_store_dwordx4 v[184:187], v251, s[24:27], s32 offen offset:64 sc1
    v_mfma_f32_32x32x16_bf16 v[16:31], a[48:51], v[148:151], v[16:31]
    s_waitcnt lgkmcnt(4)
    buffer_store_dwordx4 v[188:191], v251, s[24:27], s42 offen offset:64 sc1
    v_mfma_f32_32x32x16_bf16 v[48:63], a[52:55], v[148:151], v[48:63]
    v_mfma_f32_32x32x16_bf16 v[16:31], a[56:59], v[152:155], v[16:31]
    v_mfma_f32_32x32x16_bf16 v[48:63], a[60:63], v[152:155], v[48:63]
    s_waitcnt lgkmcnt(0)
    v_mfma_f32_32x32x16_bf16 v[16:31], a[64:67], v[156:159], v[16:31]
    v_mfma_f32_32x32x16_bf16 v[48:63], a[68:71], v[156:159], v[48:63]
    s_nop 7
    s_nop 2
    v_mul_f32 v16, v252, v16
    v_mul_f32 v17, v252, v17
    v_mul_f32 v18, v252, v18
    v_mul_f32 v19, v252, v19
    v_mul_f32 v20, v252, v20
    v_mul_f32 v21, v252, v21
    v_mul_f32 v22, v252, v22
    v_mul_f32 v23, v252, v23
    v_cvt_pk_bf16_f32 v176, v16, v17
    v_cvt_pk_bf16_f32 v177, v18, v19
    v_cvt_pk_bf16_f32 v178, v20, v21
    v_cvt_pk_bf16_f32 v179, v22, v23
    ds_write_b128 v254, v[176:179]
    v_pk_mul_f32 v[24:25], v[24:25], v[252:253] op_sel_hi:[1,0]
    v_pk_mul_f32 v[26:27], v[26:27], v[252:253] op_sel_hi:[1,0]
    v_pk_mul_f32 v[28:29], v[28:29], v[252:253] op_sel_hi:[1,0]
    v_pk_mul_f32 v[30:31], v[30:31], v[252:253] op_sel_hi:[1,0]
    v_cvt_pk_bf16_f32 v180, v24, v25
    v_cvt_pk_bf16_f32 v181, v26, v27
    v_cvt_pk_bf16_f32 v182, v28, v29
    v_cvt_pk_bf16_f32 v183, v30, v31
    v_xor_b32 v245, 16, v254
    ds_write_b128 v245, v[180:183]
    ds_read_b128 v[176:179], v255 offset:0
    ds_read_b128 v[180:183], v255 offset:1024
    v_pk_mul_f32 v[48:49], v[48:49], v[252:253] op_sel_hi:[1,0]
    v_pk_mul_f32 v[50:51], v[50:51], v[252:253] op_sel_hi:[1,0]
    v_pk_mul_f32 v[52:53], v[52:53], v[252:253] op_sel_hi:[1,0]
    v_pk_mul_f32 v[54:55], v[54:55], v[252:253] op_sel_hi:[1,0]
    v_cvt_pk_bf16_f32 v184, v48, v49
    v_cvt_pk_bf16_f32 v185, v50, v51
    v_cvt_pk_bf16_f32 v186, v52, v53
    v_cvt_pk_bf16_f32 v187, v54, v55
    s_waitcnt lgkmcnt(1)
    buffer_store_dwordx4 v[176:179], v251, s[24:27], s32 offen offset:128 sc1
    s_waitcnt lgkmcnt(0)
    buffer_store_dwordx4 v[180:183], v251, s[24:27], s42 offen offset:128 sc1
    ds_write_b128 v254, v[184:187]
    v_pk_mul_f32 v[56:57], v[56:57], v[252:253] op_sel_hi:[1,0]
    v_pk_mul_f32 v[58:59], v[58:59], v[252:253] op_sel_hi:[1,0]
    v_pk_mul_f32 v[60:61], v[60:61], v[252:253] op_sel_hi:[1,0]
    v_pk_mul_f32 v[62:63], v[62:63], v[252:253] op_sel_hi:[1,0]
    v_cvt_pk_bf16_f32 v188, v56, v57
    v_cvt_pk_bf16_f32 v189, v58, v59
    v_cvt_pk_bf16_f32 v190, v60, v61
    v_cvt_pk_bf16_f32 v191, v62, v63
    v_xor_b32 v245, 16, v254
    ds_write_b128 v245, v[188:191]
    ds_read_b128 v[184:187], v255 offset:0
    ds_read_b128 v[188:191], v255 offset:1024
    s_waitcnt lgkmcnt(1)
    buffer_store_dwordx4 v[184:187], v251, s[24:27], s32 offen offset:192 sc1
    s_waitcnt lgkmcnt(0)
    buffer_store_dwordx4 v[188:191], v251, s[24:27], s42 offen offset:192 sc1
    s_waitcnt lgkmcnt(0)
    s_barrier
    ds_read_b32 v247, v253
    s_waitcnt lgkmcnt(0)
    v_cmp_ne_u32 vcc, 0, v247
    s_cbranch_vccnz L_slow
L_done:
    s_endpgm
L_slow:
    s_nop 7
    s_nop 7
    s_waitcnt vmcnt(0) lgkmcnt(0)
    s_barrier
    s_add_u32 m0, s37, 0
    s_nop 0
    buffer_load_dwordx4 v242, s[12:15], s38 offen lds
    s_add_u32 m0, s37, 1024
    s_nop 0
    buffer_load_dwordx4 v243, s[12:15], s38 offen lds
    s_add_u32 m0, s37, 2048
    s_nop 0
    buffer_load_dwordx4 v242, s[12:15], s39 offen lds
    s_add_u32 m0, s37, 3072
    s_nop 0
    buffer_load_dwordx4 v243, s[12:15], s39 offen lds
    s_add_u32 m0, s37, 16256
    s_nop 0
    buffer_load_dwordx4 v242, s[12:15], s38 offen offset:128 lds
    s_add_u32 m0, s37, 17280
    s_nop 0
    buffer_load_dwordx4 v243, s[12:15], s38 offen offset:128 lds
    s_add_u32 m0, s37, 18304
    s_nop 0
    buffer_load_dwordx4 v242, s[12:15], s39 offen offset:128 lds
    s_add_u32 m0, s37, 19328
    s_nop 0
    buffer_load_dwordx4 v243, s[12:15], s39 offen offset:128 lds
    s_add_u32 m0, s35, 32768
    s_nop 0
    buffer_load_dwordx4 v242, s[16:19], s4 offen lds
    s_add_u32 m0, s35, 33792
    s_nop 0
    buffer_load_dwordx4 v243, s[16:19], s4 offen lds
    s_add_u32 m0, s35, 40832
    s_nop 0
    buffer_load_dwordx4 v242, s[16:19], s4 offen offset:128 lds
    s_add_u32 m0, s35, 41856
    s_nop 0
    buffer_load_dwordx4 v243, s[16:19], s4 offen offset:128 lds
    s_add_u32 m0, s35, 49152
    s_nop 0
    buffer_load_dwordx4 v242, s[16:19], s5 offen lds
    s_add_u32 m0, s35, 50176
    s_nop 0
    buffer_load_dwordx4 v243, s[16:19], s5 offen lds
    s_add_u32 m0, s35, 57216
    s_nop 0
    buffer_load_dwordx4 v242, s[16:19], s5 offen offset:128 lds
    s_add_u32 m0, s35, 58240
    s_nop 0
    buffer_load_dwordx4 v243, s[16:19], s5 offen offset:128 lds
    s_add_u32 m0, s35, 65536
    s_nop 0
    buffer_load_dwordx4 v242, s[16:19], s6 offen lds
    s_add_u32 m0, s35, 66560
    s_nop 0
    buffer_load_dwordx4 v243, s[16:19], s6 offen lds
    s_add_u32 m0, s35, 73600
    s_nop 0
    buffer_load_dwordx4 v242, s[16:19], s6 offen offset:128 lds
    s_add_u32 m0, s35, 74624
    s_nop 0
    buffer_load_dwordx4 v243, s[16:19], s6 offen offset:128 lds
    s_add_u32 m0, s35, 81920
    s_nop 0
    buffer_load_dwordx4 v242, s[16:19], s7 offen lds
    s_add_u32 m0, s35, 82944
    s_nop 0
    buffer_load_dwordx4 v243, s[16:19], s7 offen lds
    s_add_u32 m0, s35, 89984
    s_nop 0
    buffer_load_dwordx4 v242, s[16:19], s7 offen offset:128 lds
    s_add_u32 m0, s35, 91008
    s_nop 0
    buffer_load_dwordx4 v243, s[16:19], s7 offen offset:128 lds
    s_add_u32 m0, s35, 98304
    s_nop 0
    buffer_load_dwordx4 v242, s[16:19], s8 offen lds
    s_add_u32 m0, s35, 99328
    s_nop 0
    buffer_load_dwordx4 v243, s[16:19], s8 offen lds
    s_add_u32 m0, s35, 106368
    s_nop 0
    buffer_load_dwordx4 v242, s[16:19], s8 offen offset:128 lds
    s_add_u32 m0, s35, 107392
    s_nop 0
    buffer_load_dwordx4 v243, s[16:19], s8 offen offset:128 lds
    s_add_u32 m0, s35, 114688
    s_nop 0
    buffer_load_dwordx4 v242, s[16:19], s9 offen lds
    s_add_u32 m0, s35, 115712
    s_nop 0
    buffer_load_dwordx4 v243, s[16:19], s9 offen lds
    s_add_u32 m0, s35, 122752
    s_nop 0
    buffer_load_dwordx4 v242, s[16:19], s9 offen offset:128 lds
    s_add_u32 m0, s35, 123776
    s_nop 0
    buffer_load_dwordx4 v243, s[16:19], s9 offen offset:128 lds
    s_add_u32 m0, s35, 131072
    s_nop 0
    buffer_load_dwordx4 v242, s[16:19], s10 offen lds
    s_add_u32 m0, s35, 132096
    s_nop 0
    buffer_load_dwordx4 v243, s[16:19], s10 offen lds
    s_add_u32 m0, s35, 139136
    s_nop 0
    buffer_load_dwordx4 v242, s[16:19], s10 offen offset:128 lds
    s_add_u32 m0, s35, 140160
    s_nop 0
    buffer_load_dwordx4 v243, s[16:19], s10 offen offset:128 lds
    s_add_u32 m0, s35, 147456
    s_nop 0
    buffer_load_dwordx4 v242, s[16:19], s11 offen lds
    s_add_u32 m0, s35, 148480
    s_nop 0
    buffer_load_dwordx4 v243, s[16:19], s11 offen lds
    s_add_u32 m0, s35, 155520
    s_nop 0
    buffer_load_dwordx4 v242, s[16:19], s11 offen offset:128 lds
    s_add_u32 m0, s35, 156544
    s_nop 0
    buffer_load_dwordx4 v243, s[16:19], s11 offen offset:128 lds
    v_add_u32 v244, s37, v224
    v_add_u32 v245, s37, v225
    v_add_u32 v246, s37, v226
    v_add_u32 v247, s37, v227
    s_waitcnt vmcnt(0)
    s_barrier
    ds_read_b128 v[192:195], v244 offset:0
    ds_read_b128 v[196:199], v245 offset:0
    ds_read_b128 v[200:203], v246 offset:0
    ds_read_b128 v[204:207], v247 offset:0
    s_waitcnt lgkmcnt(3)
    v_lshlrev_b32 v244, 16, v192
    v_and_b32 v245, 0xffff0000, v192
    v_lshlrev_b32 v246, 16, v193
    v_and_b32 v247, 0xffff0000, v193
    v_mul_f32 v244, s100, v244
    v_mul_f32 v245, s100, v245
    v_mul_f32 v246, s100, v246
    v_mul_f32 v247, s100, v247
    v_cvt_pk_bf16_f32 v192, v244, v245
    v_cvt_pk_bf16_f32 v193, v246, v247
    v_accvgpr_write_b32 a0, v192
    v_accvgpr_write_b32 a1, v193
    v_lshlrev_b32 v244, 16, v194
    v_and_b32 v245, 0xffff0000, v194
    v_lshlrev_b32 v246, 16, v195
    v_and_b32 v247, 0xffff0000, v195
    v_mul_f32 v244, s100, v244
    v_mul_f32 v245, s100, v245
    v_mul_f32 v246, s100, v246
    v_mul_f32 v247, s100, v247
    v_cvt_pk_bf16_f32 v194, v244, v245
    v_cvt_pk_bf16_f32 v195, v246, v247
    v_accvgpr_write_b32 a2, v194
    v_accvgpr_write_b32 a3, v195
    s_waitcnt lgkmcnt(2)
    v_lshlrev_b32 v244, 16, v196
    v_and_b32 v245, 0xffff0000, v196
    v_lshlrev_b32 v246, 16, v197
    v_and_b32 v247, 0xffff0000, v197
    v_mul_f32 v244, s100, v244
    v_mul_f32 v245, s100, v245
    v_mul_f32 v246, s100, v246
    v_mul_f32 v247, s100, v247
    v_cvt_pk_bf16_f32 v196, v244, v245
    v_cvt_pk_bf16_f32 v197, v246, v247
    v_accvgpr_write_b32 a4, v196
    v_accvgpr_write_b32 a5, v197
    v_lshlrev_b32 v244, 16, v198
    v_and_b32 v245, 0xffff0000, v198
    v_lshlrev_b32 v246, 16, v199
    v_and_b32 v247, 0xffff0000, v199
    v_mul_f32 v244, s100, v244
    v_mul_f32 v245, s100, v245
    v_mul_f32 v246, s100, v246
    v_mul_f32 v247, s100, v247
    v_cvt_pk_bf16_f32 v198, v244, v245
    v_cvt_pk_bf16_f32 v199, v246, v247
    v_accvgpr_write_b32 a6, v198
    v_accvgpr_write_b32 a7, v199
    s_waitcnt lgkmcnt(1)
    v_lshlrev_b32 v244, 16, v200
    v_and_b32 v245, 0xffff0000, v200
    v_lshlrev_b32 v246, 16, v201
    v_and_b32 v247, 0xffff0000, v201
    v_mul_f32 v244, s100, v244
    v_mul_f32 v245, s100, v245
    v_mul_f32 v246, s100, v246
    v_mul_f32 v247, s100, v247
    v_cvt_pk_bf16_f32 v200, v244, v245
    v_cvt_pk_bf16_f32 v201, v246, v247
    v_accvgpr_write_b32 a8, v200
    v_accvgpr_write_b32 a9, v201
    v_lshlrev_b32 v244, 16, v202
    v_and_b32 v245, 0xffff0000, v202
    v_lshlrev_b32 v246, 16, v203
    v_and_b32 v247, 0xffff0000, v203
    v_mul_f32 v244, s100, v244
    v_mul_f32 v245, s100, v245
    v_mul_f32 v246, s100, v246
    v_mul_f32 v247, s100, v247
    v_cvt_pk_bf16_f32 v202, v244, v245
    v_cvt_pk_bf16_f32 v203, v246, v247
    v_accvgpr_write_b32 a10, v202
    v_accvgpr_write_b32 a11, v203
    s_waitcnt lgkmcnt(0)
    v_lshlrev_b32 v244, 16, v204
    v_and_b32 v245, 0xffff0000, v204
    v_lshlrev_b32 v246, 16, v205
    v_and_b32 v247, 0xffff0000, v205
    v_mul_f32 v244, s100, v244
    v_mul_f32 v245, s100, v245
    v_mul_f32 v246, s100, v246
    v_mul_f32 v247, s100, v247
    v_cvt_pk_bf16_f32 v204, v244, v245
    v_cvt_pk_bf16_f32 v205, v246, v247
    v_accvgpr_write_b32 a12, v204
    v_accvgpr_write_b32 a13, v205
    v_lshlrev_b32 v244, 16, v206
    v_and_b32 v245, 0xffff0000, v206
    v_lshlrev_b32 v246, 16, v207
    v_and_b32 v247, 0xffff0000, v207
    v_mul_f32 v244, s100, v244
    v_mul_f32 v245, s100, v245
    v_mul_f32 v246, s100, v246
    v_mul_f32 v247, s100, v247
    v_cvt_pk_bf16_f32 v206, v244, v245
    v_cvt_pk_bf16_f32 v207, v246, v247
    v_accvgpr_write_b32 a14, v206
    v_accvgpr_write_b32 a15, v207
    v_add_u32 v244, s37, v224
    v_add_u32 v245, s37, v225
    v_add_u32 v246, s37, v226
    v_add_u32 v247, s37, v227
    ds_read_b128 v[192:195], v244 offset:16384
    ds_read_b128 v[196:199], v245 offset:16384
    ds_read_b128 v[200:203], v246 offset:16384
    ds_read_b128 v[204:207], v247 offset:16384
    s_waitcnt lgkmcnt(3)
    v_lshlrev_b32 v244, 16, v192
    v_and_b32 v245, 0xffff0000, v192
    v_lshlrev_b32 v246, 16, v193
    v_and_b32 v247, 0xffff0000, v193
    v_mul_f32 v244, s100, v244
    v_mul_f32 v245, s100, v245
    v_mul_f32 v246, s100, v246
    v_mul_f32 v247, s100, v247
    v_cvt_pk_bf16_f32 v192, v244, v245
    v_cvt_pk_bf16_f32 v193, v246, v247
    v_accvgpr_write_b32 a16, v192
    v_accvgpr_write_b32 a17, v193
    v_lshlrev_b32 v244, 16, v194
    v_and_b32 v245, 0xffff0000, v194
    v_lshlrev_b32 v246, 16, v195
    v_and_b32 v247, 0xffff0000, v195
    v_mul_f32 v244, s100, v244
    v_mul_f32 v245, s100, v245
    v_mul_f32 v246, s100, v246
    v_mul_f32 v247, s100, v247
    v_cvt_pk_bf16_f32 v194, v244, v245
    v_cvt_pk_bf16_f32 v195, v246, v247
    v_accvgpr_write_b32 a18, v194
    v_accvgpr_write_b32 a19, v195
    s_waitcnt lgkmcnt(2)
    v_lshlrev_b32 v244, 16, v196
    v_and_b32 v245, 0xffff0000, v196
    v_lshlrev_b32 v246, 16, v197
    v_and_b32 v247, 0xffff0000, v197
    v_mul_f32 v244, s100, v244
    v_mul_f32 v245, s100, v245
    v_mul_f32 v246, s100, v246
    v_mul_f32 v247, s100, v247
    v_cvt_pk_bf16_f32 v196, v244, v245
    v_cvt_pk_bf16_f32 v197, v246, v247
    v_accvgpr_write_b32 a20, v196
    v_accvgpr_write_b32 a21, v197
    v_lshlrev_b32 v244, 16, v198
    v_and_b32 v245, 0xffff0000, v198
    v_lshlrev_b32 v246, 16, v199
    v_and_b32 v247, 0xffff0000, v199
    v_mul_f32 v244, s100, v244
    v_mul_f32 v245, s100, v245
    v_mul_f32 v246, s100, v246
    v_mul_f32 v247, s100, v247
    v_cvt_pk_bf16_f32 v198, v244, v245
    v_cvt_pk_bf16_f32 v199, v246, v247
    v_accvgpr_write_b32 a22, v198
    v_accvgpr_write_b32 a23, v199
    s_waitcnt lgkmcnt(1)
    v_lshlrev_b32 v244, 16, v200
    v_and_b32 v245, 0xffff0000, v200
    v_lshlrev_b32 v246, 16, v201
    v_and_b32 v247, 0xffff0000, v201
    v_mul_f32 v244, s100, v244
    v_mul_f32 v245, s100, v245
    v_mul_f32 v246, s100, v246
    v_mul_f32 v247, s100, v247
    v_cvt_pk_bf16_f32 v200, v244, v245
    v_cvt_pk_bf16_f32 v201, v246, v247
    v_accvgpr_write_b32 a24, v200
    v_accvgpr_write_b32 a25, v201
    v_lshlrev_b32 v244, 16, v202
    v_and_b32 v245, 0xffff0000, v202
    v_lshlrev_b32 v246, 16, v203
    v_and_b32 v247, 0xffff0000, v203
    v_mul_f32 v244, s100, v244
    v_mul_f32 v245, s100, v245
    v_mul_f32 v246, s100, v246
    v_mul_f32 v247, s100, v247
    v_cvt_pk_bf16_f32 v202, v244, v245
    v_cvt_pk_bf16_f32 v203, v246, v247
    v_accvgpr_write_b32 a26, v202
    v_accvgpr_write_b32 a27, v203
    s_waitcnt lgkmcnt(0)
    v_lshlrev_b32 v244, 16, v204
    v_and_b32 v245, 0xffff0000, v204
    v_lshlrev_b32 v246, 16, v205
    v_and_b32 v247, 0xffff0000, v205
    v_mul_f32 v244, s100, v244
    v_mul_f32 v245, s100, v245
    v_mul_f32 v246, s100, v246
    v_mul_f32 v247, s100, v247
    v_cvt_pk_bf16_f32 v204, v244, v245
    v_cvt_pk_bf16_f32 v205, v246, v247
    v_accvgpr_write_b32 a28, v204
    v_accvgpr_write_b32 a29, v205
    v_lshlrev_b32 v244, 16, v206
    v_and_b32 v245, 0xffff0000, v206
    v_lshlrev_b32 v246, 16, v207
    v_and_b32 v247, 0xffff0000, v207
    v_mul_f32 v244, s100, v244
    v_mul_f32 v245, s100, v245
    v_mul_f32 v246, s100, v246
    v_mul_f32 v247, s100, v247
    v_cvt_pk_bf16_f32 v206, v244, v245
    v_cvt_pk_bf16_f32 v207, v246, v247
    v_accvgpr_write_b32 a30, v206
    v_accvgpr_write_b32 a31, v207
    ds_read_b128 v[32:35], v224 offset:32768
    ds_read_b128 v[36:39], v225 offset:32768
    ds_read_b128 v[40:43], v226 offset:32768
    ds_read_b128 v[44:47], v227 offset:32768
    ds_read_b128 v[48:51], v224 offset:40960
    ds_read_b128 v[52:55], v225 offset:40960
    ds_read_b128 v[56:59], v226 offset:40960
    ds_read_b128 v[60:63], v227 offset:40960
    s_waitcnt lgkmcnt(7)
    v_mfma_f32_32x32x16_bf16 v[0:15], v[32:35], a[0:3], 0
    s_waitcnt lgkmcnt(6)
    v_mfma_f32_32x32x16_bf16 v[0:15], v[36:39], a[4:7], v[0:15]
    s_waitcnt lgkmcnt(5)
    v_mfma_f32_32x32x16_bf16 v[0:15], v[40:43], a[8:11], v[0:15]
    s_waitcnt lgkmcnt(4)
    v_mfma_f32_32x32x16_bf16 v[0:15], v[44:47], a[12:15], v[0:15]
    s_waitcnt lgkmcnt(3)
    v_mfma_f32_32x32x16_bf16 v[0:15], v[48:51], a[16:19], v[0:15]
    s_waitcnt lgkmcnt(2)
    v_mfma_f32_32x32x16_bf16 v[0:15], v[52:55], a[20:23], v[0:15]
    s_waitcnt lgkmcnt(1)
    v_mfma_f32_32x32x16_bf16 v[0:15], v[56:59], a[24:27], v[0:15]
    s_waitcnt lgkmcnt(0)
    v_mfma_f32_32x32x16_bf16 v[0:15], v[60:63], a[28:31], v[0:15]
    s_nop 7
    s_nop 3
    v_max_f32 v16, v0, v1
    v_max3_f32 v16, v16, v2, v3
    v_max3_f32 v16, v16, v4, v5
    v_max3_f32 v16, v16, v6, v7
    v_max3_f32 v16, v16, v8, v9
    v_max3_f32 v16, v16, v10, v11
    v_max3_f32 v16, v16, v12, v13
    v_max3_f32 v16, v16, v14, v15
    ds_read_b128 v[32:35], v224 offset:36864
    ds_read_b128 v[36:39], v225 offset:36864
    ds_read_b128 v[40:43], v226 offset:36864
    ds_read_b128 v[44:47], v227 offset:36864
    ds_read_b128 v[48:51], v224 offset:45056
    ds_read_b128 v[52:55], v225 offset:45056
    ds_read_b128 v[56:59], v226 offset:45056
    ds_read_b128 v[60:63], v227 offset:45056
    s_waitcnt lgkmcnt(7)
    v_mfma_f32_32x32x16_bf16 v[0:15], v[32:35], a[0:3], 0
    s_waitcnt lgkmcnt(6)
    v_mfma_f32_32x32x16_bf16 v[0:15], v[36:39], a[4:7], v[0:15]
    s_waitcnt lgkmcnt(5)
    v_mfma_f32_32x32x16_bf16 v[0:15], v[40:43], a[8:11], v[0:15]
    s_waitcnt lgkmcnt(4)
    v_mfma_f32_32x32x16_bf16 v[0:15], v[44:47], a[12:15], v[0:15]
    s_waitcnt lgkmcnt(3)
    v_mfma_f32_32x32x16_bf16 v[0:15], v[48:51], a[16:19], v[0:15]
    s_waitcnt lgkmcnt(2)
    v_mfma_f32_32x32x16_bf16 v[0:15], v[52:55], a[20:23], v[0:15]
    s_waitcnt lgkmcnt(1)
    v_mfma_f32_32x32x16_bf16 v[0:15], v[56:59], a[24:27], v[0:15]
    s_waitcnt lgkmcnt(0)
    v_mfma_f32_32x32x16_bf16 v[0:15], v[60:63], a[28:31], v[0:15]
    s_nop 7
    s_nop 3
    v_max3_f32 v16, v16, v0, v1
    v_max3_f32 v16, v16, v2, v3
    v_max3_f32 v16, v16, v4, v5
    v_max3_f32 v16, v16, v6, v7
    v_max3_f32 v16, v16, v8, v9
    v_max3_f32 v16, v16, v10, v11
    v_max3_f32 v16, v16, v12, v13
    v_max3_f32 v16, v16, v14, v15
    ds_read_b128 v[32:35], v224 offset:49152
    ds_read_b128 v[36:39], v225 offset:49152
    ds_read_b128 v[40:43], v226 offset:49152
    ds_read_b128 v[44:47], v227 offset:49152
    ds_read_b128 v[48:51], v224 offset:57344
    ds_read_b128 v[52:55], v225 offset:57344
    ds_read_b128 v[56:59], v226 offset:57344
    ds_read_b128 v[60:63], v227 offset:57344
    s_waitcnt lgkmcnt(7)
    v_mfma_f32_32x32x16_bf16 v[0:15], v[32:35], a[0:3], 0
    s_waitcnt lgkmcnt(6)
    v_mfma_f32_32x32x16_bf16 v[0:15], v[36:39], a[4:7], v[0:15]
    s_waitcnt lgkmcnt(5)
    v_mfma_f32_32x32x16_bf16 v[0:15], v[40:43], a[8:11], v[0:15]
    s_waitcnt lgkmcnt(4)
    v_mfma_f32_32x32x16_bf16 v[0:15], v[44:47], a[12:15], v[0:15]
    s_waitcnt lgkmcnt(3)
    v_mfma_f32_32x32x16_bf16 v[0:15], v[48:51], a[16:19], v[0:15]
    s_waitcnt lgkmcnt(2)
    v_mfma_f32_32x32x16_bf16 v[0:15], v[52:55], a[20:23], v[0:15]
    s_waitcnt lgkmcnt(1)
    v_mfma_f32_32x32x16_bf16 v[0:15], v[56:59], a[24:27], v[0:15]
    s_waitcnt lgkmcnt(0)
    v_mfma_f32_32x32x16_bf16 v[0:15], v[60:63], a[28:31], v[0:15]
    s_nop 7
    s_nop 3
    v_max3_f32 v16, v16, v0, v1
    v_max3_f32 v16, v16, v2, v3
    v_max3_f32 v16, v16, v4, v5
    v_max3_f32 v16, v16, v6, v7
    v_max3_f32 v16, v16, v8, v9
    v_max3_f32 v16, v16, v10, v11
    v_max3_f32 v16, v16, v12, v13
    v_max3_f32 v16, v16, v14, v15
    ds_read_b128 v[32:35], v224 offset:53248
    ds_read_b128 v[36:39], v225 offset:53248
    ds_read_b128 v[40:43], v226 offset:53248
    ds_read_b128 v[44:47], v227 offset:53248
    ds_read_b128 v[48:51], v224 offset:61440
    ds_read_b128 v[52:55], v225 offset:61440
    ds_read_b128 v[56:59], v226 offset:61440
    ds_read_b128 v[60:63], v227 offset:61440
    s_waitcnt lgkmcnt(7)
    v_mfma_f32_32x32x16_bf16 v[0:15], v[32:35], a[0:3], 0
    s_waitcnt lgkmcnt(6)
    v_mfma_f32_32x32x16_bf16 v[0:15], v[36:39], a[4:7], v[0:15]
    s_waitcnt lgkmcnt(5)
    v_mfma_f32_32x32x16_bf16 v[0:15], v[40:43], a[8:11], v[0:15]
    s_waitcnt lgkmcnt(4)
    v_mfma_f32_32x32x16_bf16 v[0:15], v[44:47], a[12:15], v[0:15]
    s_waitcnt lgkmcnt(3)
    v_mfma_f32_32x32x16_bf16 v[0:15], v[48:51], a[16:19], v[0:15]
    s_waitcnt lgkmcnt(2)
    v_mfma_f32_32x32x16_bf16 v[0:15], v[52:55], a[20:23], v[0:15]
    s_waitcnt lgkmcnt(1)
    v_mfma_f32_32x32x16_bf16 v[0:15], v[56:59], a[24:27], v[0:15]
    s_waitcnt lgkmcnt(0)
    v_mfma_f32_32x32x16_bf16 v[0:15], v[60:63], a[28:31], v[0:15]
    s_nop 7
    s_nop 3
    v_max3_f32 v16, v16, v0, v1
    v_max3_f32 v16, v16, v2, v3
    v_max3_f32 v16, v16, v4, v5
    v_max3_f32 v16, v16, v6, v7
    v_max3_f32 v16, v16, v8, v9
    v_max3_f32 v16, v16, v10, v11
    v_max3_f32 v16, v16, v12, v13
    v_max3_f32 v16, v16, v14, v15
    ds_read_b128 v[32:35], v228 offset:0
    ds_read_b128 v[36:39], v229 offset:0
    ds_read_b128 v[40:43], v230 offset:0
    ds_read_b128 v[44:47], v231 offset:0
    ds_read_b128 v[48:51], v228 offset:8192
    ds_read_b128 v[52:55], v229 offset:8192
    ds_read_b128 v[56:59], v230 offset:8192
    ds_read_b128 v[60:63], v231 offset:8192
    s_waitcnt lgkmcnt(7)
    v_mfma_f32_32x32x16_bf16 v[0:15], v[32:35], a[0:3], 0
    s_waitcnt lgkmcnt(6)
    v_mfma_f32_32x32x16_bf16 v[0:15], v[36:39], a[4:7], v[0:15]
    s_waitcnt lgkmcnt(5)
    v_mfma_f32_32x32x16_bf16 v[0:15], v[40:43], a[8:11], v[0:15]
    s_waitcnt lgkmcnt(4)
    v_mfma_f32_32x32x16_bf16 v[0:15], v[44:47], a[12:15], v[0:15]
    s_waitcnt lgkmcnt(3)
    v_mfma_f32_32x32x16_bf16 v[0:15], v[48:51], a[16:19], v[0:15]
    s_waitcnt lgkmcnt(2)
    v_mfma_f32_32x32x16_bf16 v[0:15], v[52:55], a[20:23], v[0:15]
    s_waitcnt lgkmcnt(1)
    v_mfma_f32_32x32x16_bf16 v[0:15], v[56:59], a[24:27], v[0:15]
    s_waitcnt lgkmcnt(0)
    v_mfma_f32_32x32x16_bf16 v[0:15], v[60:63], a[28:31], v[0:15]
    s_nop 7
    s_nop 3
    v_max3_f32 v16, v16, v0, v1
    v_max3_f32 v16, v16, v2, v3
    v_max3_f32 v16, v16, v4, v5
    v_max3_f32 v16, v16, v6, v7
    v_max3_f32 v16, v16, v8, v9
    v_max3_f32 v16, v16, v10, v11
    v_max3_f32 v16, v16, v12, v13
    v_max3_f32 v16, v16, v14, v15
    ds_read_b128 v[32:35], v228 offset:4096
    ds_read_b128 v[36:39], v229 offset:4096
    ds_read_b128 v[40:43], v230 offset:4096
    ds_read_b128 v[44:47], v231 offset:4096
    ds_read_b128 v[48:51], v228 offset:12288
    ds_read_b128 v[52:55], v229 offset:12288
    ds_read_b128 v[56:59], v230 offset:12288
    ds_read_b128 v[60:63], v231 offset:12288
    s_waitcnt lgkmcnt(7)
    v_mfma_f32_32x32x16_bf16 v[0:15], v[32:35], a[0:3], 0
    s_waitcnt lgkmcnt(6)
    v_mfma_f32_32x32x16_bf16 v[0:15], v[36:39], a[4:7], v[0:15]
    s_waitcnt lgkmcnt(5)
    v_mfma_f32_32x32x16_bf16 v[0:15], v[40:43], a[8:11], v[0:15]
    s_waitcnt lgkmcnt(4)
    v_mfma_f32_32x32x16_bf16 v[0:15], v[44:47], a[12:15], v[0:15]
    s_waitcnt lgkmcnt(3)
    v_mfma_f32_32x32x16_bf16 v[0:15], v[48:51], a[16:19], v[0:15]
    s_waitcnt lgkmcnt(2)
    v_mfma_f32_32x32x16_bf16 v[0:15], v[52:55], a[20:23], v[0:15]
    s_waitcnt lgkmcnt(1)
    v_mfma_f32_32x32x16_bf16 v[0:15], v[56:59], a[24:27], v[0:15]
    s_waitcnt lgkmcnt(0)
    v_mfma_f32_32x32x16_bf16 v[0:15], v[60:63], a[28:31], v[0:15]
    s_nop 7
    s_nop 3
    v_max3_f32 v16, v16, v0, v1
    v_max3_f32 v16, v16, v2, v3
    v_max3_f32 v16, v16, v4, v5
    v_max3_f32 v16, v16, v6, v7
    v_max3_f32 v16, v16, v8, v9
    v_max3_f32 v16, v16, v10, v11
    v_max3_f32 v16, v16, v12, v13
    v_max3_f32 v16, v16, v14, v15
    ds_read_b128 v[32:35], v228 offset:16384
    ds_read_b128 v[36:39], v229 offset:16384
    ds_read_b128 v[40:43], v230 offset:16384
    ds_read_b128 v[44:47], v231 offset:16384
    ds_read_b128 v[48:51], v228 offset:24576
    ds_read_b128 v[52:55], v229 offset:24576
    ds_read_b128 v[56:59], v230 offset:24576
    ds_read_b128 v[60:63], v231 offset:24576
    s_waitcnt lgkmcnt(7)
    v_mfma_f32_32x32x16_bf16 v[0:15], v[32:35], a[0:3], 0
    s_waitcnt lgkmcnt(6)
    v_mfma_f32_32x32x16_bf16 v[0:15], v[36:39], a[4:7], v[0:15]
    s_waitcnt lgkmcnt(5)
    v_mfma_f32_32x32x16_bf16 v[0:15], v[40:43], a[8:11], v[0:15]
    s_waitcnt lgkmcnt(4)
    v_mfma_f32_32x32x16_bf16 v[0:15], v[44:47], a[12:15], v[0:15]
    s_waitcnt lgkmcnt(3)
    v_mfma_f32_32x32x16_bf16 v[0:15], v[48:51], a[16:19], v[0:15]
    s_waitcnt lgkmcnt(2)
    v_mfma_f32_32x32x16_bf16 v[0:15], v[52:55], a[20:23], v[0:15]
    s_waitcnt lgkmcnt(1)
    v_mfma_f32_32x32x16_bf16 v[0:15], v[56:59], a[24:27], v[0:15]
    s_waitcnt lgkmcnt(0)
    v_mfma_f32_32x32x16_bf16 v[0:15], v[60:63], a[28:31], v[0:15]
    s_nop 7
    s_nop 3
    v_max3_f32 v16, v16, v0, v1
    v_max3_f32 v16, v16, v2, v3
    v_max3_f32 v16, v16, v4, v5
    v_max3_f32 v16, v16, v6, v7
    v_max3_f32 v16, v16, v8, v9
    v_max3_f32 v16, v16, v10, v11
    v_max3_f32 v16, v16, v12, v13
    v_max3_f32 v16, v16, v14, v15
    ds_read_b128 v[32:35], v228 offset:20480
    ds_read_b128 v[36:39], v229 offset:20480
    ds_read_b128 v[40:43], v230 offset:20480
    ds_read_b128 v[44:47], v231 offset:20480
    ds_read_b128 v[48:51], v228 offset:28672
    ds_read_b128 v[52:55], v229 offset:28672
    ds_read_b128 v[56:59], v230 offset:28672
    ds_read_b128 v[60:63], v231 offset:28672
    s_waitcnt lgkmcnt(7)
    v_mfma_f32_32x32x16_bf16 v[0:15], v[32:35], a[0:3], 0
    s_waitcnt lgkmcnt(6)
    v_mfma_f32_32x32x16_bf16 v[0:15], v[36:39], a[4:7], v[0:15]
    s_waitcnt lgkmcnt(5)
    v_mfma_f32_32x32x16_bf16 v[0:15], v[40:43], a[8:11], v[0:15]
    s_waitcnt lgkmcnt(4)
    v_mfma_f32_32x32x16_bf16 v[0:15], v[44:47], a[12:15], v[0:15]
    s_waitcnt lgkmcnt(3)
    v_mfma_f32_32x32x16_bf16 v[0:15], v[48:51], a[16:19], v[0:15]
    s_waitcnt lgkmcnt(2)
    v_mfma_f32_32x32x16_bf16 v[0:15], v[52:55], a[20:23], v[0:15]
    s_waitcnt lgkmcnt(1)
    v_mfma_f32_32x32x16_bf16 v[0:15], v[56:59], a[24:27], v[0:15]
    s_waitcnt lgkmcnt(0)
    v_mfma_f32_32x32x16_bf16 v[0:15], v[60:63], a[28:31], v[0:15]
    s_nop 7
    s_nop 3
    v_max3_f32 v16, v16, v0, v1
    v_max3_f32 v16, v16, v2, v3
    v_max3_f32 v16, v16, v4, v5
    v_max3_f32 v16, v16, v6, v7
    v_max3_f32 v16, v16, v8, v9
    v_max3_f32 v16, v16, v10, v11
    v_max3_f32 v16, v16, v12, v13
    v_max3_f32 v16, v16, v14, v15
    ds_read_b128 v[32:35], v228 offset:32768
    ds_read_b128 v[36:39], v229 offset:32768
    ds_read_b128 v[40:43], v230 offset:32768
    ds_read_b128 v[44:47], v231 offset:32768
    ds_read_b128 v[48:51], v228 offset:40960
    ds_read_b128 v[52:55], v229 offset:40960
    ds_read_b128 v[56:59], v230 offset:40960
    ds_read_b128 v[60:63], v231 offset:40960
    s_waitcnt lgkmcnt(7)
    v_mfma_f32_32x32x16_bf16 v[0:15], v[32:35], a[0:3], 0
    s_waitcnt lgkmcnt(6)
    v_mfma_f32_32x32x16_bf16 v[0:15], v[36:39], a[4:7], v[0:15]
    s_waitcnt lgkmcnt(5)
    v_mfma_f32_32x32x16_bf16 v[0:15], v[40:43], a[8:11], v[0:15]
    s_waitcnt lgkmcnt(4)
    v_mfma_f32_32x32x16_bf16 v[0:15], v[44:47], a[12:15], v[0:15]
    s_waitcnt lgkmcnt(3)
    v_mfma_f32_32x32x16_bf16 v[0:15], v[48:51], a[16:19], v[0:15]
    s_waitcnt lgkmcnt(2)
    v_mfma_f32_32x32x16_bf16 v[0:15], v[52:55], a[20:23], v[0:15]
    s_waitcnt lgkmcnt(1)
    v_mfma_f32_32x32x16_bf16 v[0:15], v[56:59], a[24:27], v[0:15]
    s_waitcnt lgkmcnt(0)
    v_mfma_f32_32x32x16_bf16 v[0:15], v[60:63], a[28:31], v[0:15]
    s_nop 7
    s_nop 3
    v_max3_f32 v16, v16, v0, v1
    v_max3_f32 v16, v16, v2, v3
    v_max3_f32 v16, v16, v4, v5
    v_max3_f32 v16, v16, v6, v7
    v_max3_f32 v16, v16, v8, v9
    v_max3_f32 v16, v16, v10, v11
    v_max3_f32 v16, v16, v12, v13
    v_max3_f32 v16, v16, v14, v15
    ds_read_b128 v[32:35], v228 offset:36864
    ds_read_b128 v[36:39], v229 offset:36864
    ds_read_b128 v[40:43], v230 offset:36864
    ds_read_b128 v[44:47], v231 offset:36864
    ds_read_b128 v[48:51], v228 offset:45056
    ds_read_b128 v[52:55], v229 offset:45056
    ds_read_b128 v[56:59], v230 offset:45056
    ds_read_b128 v[60:63], v231 offset:45056
    s_waitcnt lgkmcnt(7)
    v_mfma_f32_32x32x16_bf16 v[0:15], v[32:35], a[0:3], 0
    s_waitcnt lgkmcnt(6)
    v_mfma_f32_32x32x16_bf16 v[0:15], v[36:39], a[4:7], v[0:15]
    s_waitcnt lgkmcnt(5)
    v_mfma_f32_32x32x16_bf16 v[0:15], v[40:43], a[8:11], v[0:15]
    s_waitcnt lgkmcnt(4)
    v_mfma_f32_32x32x16_bf16 v[0:15], v[44:47], a[12:15], v[0:15]
    s_waitcnt lgkmcnt(3)
    v_mfma_f32_32x32x16_bf16 v[0:15], v[48:51], a[16:19], v[0:15]
    s_waitcnt lgkmcnt(2)
    v_mfma_f32_32x32x16_bf16 v[0:15], v[52:55], a[20:23], v[0:15]
    s_waitcnt lgkmcnt(1)
    v_mfma_f32_32x32x16_bf16 v[0:15], v[56:59], a[24:27], v[0:15]
    s_waitcnt lgkmcnt(0)
    v_mfma_f32_32x32x16_bf16 v[0:15], v[60:63], a[28:31], v[0:15]
    s_nop 7
    s_nop 3
    v_max3_f32 v16, v16, v0, v1
    v_max3_f32 v16, v16, v2, v3
    v_max3_f32 v16, v16, v4, v5
    v_max3_f32 v16, v16, v6, v7
    v_max3_f32 v16, v16, v8, v9
    v_max3_f32 v16, v16, v10, v11
    v_max3_f32 v16, v16, v12, v13
    v_max3_f32 v16, v16, v14, v15
    ds_read_b128 v[32:35], v228 offset:49152
    ds_read_b128 v[36:39], v229 offset:49152
    ds_read_b128 v[40:43], v230 offset:49152
    ds_read_b128 v[44:47], v231 offset:49152
    ds_read_b128 v[48:51], v228 offset:57344
    ds_read_b128 v[52:55], v229 offset:57344
    ds_read_b128 v[56:59], v230 offset:57344
    ds_read_b128 v[60:63], v231 offset:57344
    s_waitcnt lgkmcnt(7)
    v_mfma_f32_32x32x16_bf16 v[0:15], v[32:35], a[0:3], 0
    s_waitcnt lgkmcnt(6)
    v_mfma_f32_32x32x16_bf16 v[0:15], v[36:39], a[4:7], v[0:15]
    s_waitcnt lgkmcnt(5)
    v_mfma_f32_32x32x16_bf16 v[0:15], v[40:43], a[8:11], v[0:15]
    s_waitcnt lgkmcnt(4)
    v_mfma_f32_32x32x16_bf16 v[0:15], v[44:47], a[12:15], v[0:15]
    s_waitcnt lgkmcnt(3)
    v_mfma_f32_32x32x16_bf16 v[0:15], v[48:51], a[16:19], v[0:15]
    s_waitcnt lgkmcnt(2)
    v_mfma_f32_32x32x16_bf16 v[0:15], v[52:55], a[20:23], v[0:15]
    s_waitcnt lgkmcnt(1)
    v_mfma_f32_32x32x16_bf16 v[0:15], v[56:59], a[24:27], v[0:15]
    s_waitcnt lgkmcnt(0)
    v_mfma_f32_32x32x16_bf16 v[0:15], v[60:63], a[28:31], v[0:15]
    s_nop 7
    s_nop 3
    v_max3_f32 v16, v16, v0, v1
    v_max3_f32 v16, v16, v2, v3
    v_max3_f32 v16, v16, v4, v5
    v_max3_f32 v16, v16, v6, v7
    v_max3_f32 v16, v16, v8, v9
    v_max3_f32 v16, v16, v10, v11
    v_max3_f32 v16, v16, v12, v13
    v_max3_f32 v16, v16, v14, v15
    ds_read_b128 v[32:35], v228 offset:53248
    ds_read_b128 v[36:39], v229 offset:53248
    ds_read_b128 v[40:43], v230 offset:53248
    ds_read_b128 v[44:47], v231 offset:53248
    ds_read_b128 v[48:51], v228 offset:61440
    ds_read_b128 v[52:55], v229 offset:61440
    ds_read_b128 v[56:59], v230 offset:61440
    ds_read_b128 v[60:63], v231 offset:61440
    s_waitcnt lgkmcnt(7)
    v_mfma_f32_32x32x16_bf16 v[0:15], v[32:35], a[0:3], 0
    s_waitcnt lgkmcnt(6)
    v_mfma_f32_32x32x16_bf16 v[0:15], v[36:39], a[4:7], v[0:15]
    s_waitcnt lgkmcnt(5)
    v_mfma_f32_32x32x16_bf16 v[0:15], v[40:43], a[8:11], v[0:15]
    s_waitcnt lgkmcnt(4)
    v_mfma_f32_32x32x16_bf16 v[0:15], v[44:47], a[12:15], v[0:15]
    s_waitcnt lgkmcnt(3)
    v_mfma_f32_32x32x16_bf16 v[0:15], v[48:51], a[16:19], v[0:15]
    s_waitcnt lgkmcnt(2)
    v_mfma_f32_32x32x16_bf16 v[0:15], v[52:55], a[20:23], v[0:15]
    s_waitcnt lgkmcnt(1)
    v_mfma_f32_32x32x16_bf16 v[0:15], v[56:59], a[24:27], v[0:15]
    s_waitcnt lgkmcnt(0)
    v_mfma_f32_32x32x16_bf16 v[0:15], v[60:63], a[28:31], v[0:15]
    s_nop 7
    s_nop 3
    v_max3_f32 v16, v16, v0, v1
    v_max3_f32 v16, v16, v2, v3
    v_max3_f32 v16, v16, v4, v5
    v_max3_f32 v16, v16, v6, v7
    v_max3_f32 v16, v16, v8, v9
    v_max3_f32 v16, v16, v10, v11
    v_max3_f32 v16, v16, v12, v13
    v_max3_f32 v16, v16, v14, v15
    ds_read_b128 v[32:35], v232 offset:0
    ds_read_b128 v[36:39], v233 offset:0
    ds_read_b128 v[40:43], v234 offset:0
    ds_read_b128 v[44:47], v235 offset:0
    ds_read_b128 v[48:51], v232 offset:8192
    ds_read_b128 v[52:55], v233 offset:8192
    ds_read_b128 v[56:59], v234 offset:8192
    ds_read_b128 v[60:63], v235 offset:8192
    s_waitcnt lgkmcnt(7)
    v_mfma_f32_32x32x16_bf16 v[0:15], v[32:35], a[0:3], 0
    s_waitcnt lgkmcnt(6)
    v_mfma_f32_32x32x16_bf16 v[0:15], v[36:39], a[4:7], v[0:15]
    s_waitcnt lgkmcnt(5)
    v_mfma_f32_32x32x16_bf16 v[0:15], v[40:43], a[8:11], v[0:15]
    s_waitcnt lgkmcnt(4)
    v_mfma_f32_32x32x16_bf16 v[0:15], v[44:47], a[12:15], v[0:15]
    s_waitcnt lgkmcnt(3)
    v_mfma_f32_32x32x16_bf16 v[0:15], v[48:51], a[16:19], v[0:15]
    s_waitcnt lgkmcnt(2)
    v_mfma_f32_32x32x16_bf16 v[0:15], v[52:55], a[20:23], v[0:15]
    s_waitcnt lgkmcnt(1)
    v_mfma_f32_32x32x16_bf16 v[0:15], v[56:59], a[24:27], v[0:15]
    s_waitcnt lgkmcnt(0)
    v_mfma_f32_32x32x16_bf16 v[0:15], v[60:63], a[28:31], v[0:15]
    s_nop 7
    s_nop 3
    v_max3_f32 v16, v16, v0, v1
    v_max3_f32 v16, v16, v2, v3
    v_max3_f32 v16, v16, v4, v5
    v_max3_f32 v16, v16, v6, v7
    v_max3_f32 v16, v16, v8, v9
    v_max3_f32 v16, v16, v10, v11
    v_max3_f32 v16, v16, v12, v13
    v_max3_f32 v16, v16, v14, v15
    ds_read_b128 v[32:35], v232 offset:4096
    ds_read_b128 v[36:39], v233 offset:4096
    ds_read_b128 v[40:43], v234 offset:4096
    ds_read_b128 v[44:47], v235 offset:4096
    ds_read_b128 v[48:51], v232 offset:12288
    ds_read_b128 v[52:55], v233 offset:12288
    ds_read_b128 v[56:59], v234 offset:12288
    ds_read_b128 v[60:63], v235 offset:12288
    s_waitcnt lgkmcnt(7)
    v_mfma_f32_32x32x16_bf16 v[0:15], v[32:35], a[0:3], 0
    s_waitcnt lgkmcnt(6)
    v_mfma_f32_32x32x16_bf16 v[0:15], v[36:39], a[4:7], v[0:15]
    s_waitcnt lgkmcnt(5)
    v_mfma_f32_32x32x16_bf16 v[0:15], v[40:43], a[8:11], v[0:15]
    s_waitcnt lgkmcnt(4)
    v_mfma_f32_32x32x16_bf16 v[0:15], v[44:47], a[12:15], v[0:15]
    s_waitcnt lgkmcnt(3)
    v_mfma_f32_32x32x16_bf16 v[0:15], v[48:51], a[16:19], v[0:15]
    s_waitcnt lgkmcnt(2)
    v_mfma_f32_32x32x16_bf16 v[0:15], v[52:55], a[20:23], v[0:15]
    s_waitcnt lgkmcnt(1)
    v_mfma_f32_32x32x16_bf16 v[0:15], v[56:59], a[24:27], v[0:15]
    s_waitcnt lgkmcnt(0)
    v_mfma_f32_32x32x16_bf16 v[0:15], v[60:63], a[28:31], v[0:15]
    s_nop 7
    s_nop 3
    v_max3_f32 v16, v16, v0, v1
    v_max3_f32 v16, v16, v2, v3
    v_max3_f32 v16, v16, v4, v5
    v_max3_f32 v16, v16, v6, v7
    v_max3_f32 v16, v16, v8, v9
    v_max3_f32 v16, v16, v10, v11
    v_max3_f32 v16, v16, v12, v13
    v_max3_f32 v16, v16, v14, v15
    ds_read_b128 v[32:35], v232 offset:16384
    ds_read_b128 v[36:39], v233 offset:16384
    ds_read_b128 v[40:43], v234 offset:16384
    ds_read_b128 v[44:47], v235 offset:16384
    ds_read_b128 v[48:51], v232 offset:24576
    ds_read_b128 v[52:55], v233 offset:24576
    ds_read_b128 v[56:59], v234 offset:24576
    ds_read_b128 v[60:63], v235 offset:24576
    s_waitcnt lgkmcnt(7)
    v_mfma_f32_32x32x16_bf16 v[0:15], v[32:35], a[0:3], 0
    s_waitcnt lgkmcnt(6)
    v_mfma_f32_32x32x16_bf16 v[0:15], v[36:39], a[4:7], v[0:15]
    s_waitcnt lgkmcnt(5)
    v_mfma_f32_32x32x16_bf16 v[0:15], v[40:43], a[8:11], v[0:15]
    s_waitcnt lgkmcnt(4)
    v_mfma_f32_32x32x16_bf16 v[0:15], v[44:47], a[12:15], v[0:15]
    s_waitcnt lgkmcnt(3)
    v_mfma_f32_32x32x16_bf16 v[0:15], v[48:51], a[16:19], v[0:15]
    s_waitcnt lgkmcnt(2)
    v_mfma_f32_32x32x16_bf16 v[0:15], v[52:55], a[20:23], v[0:15]
    s_waitcnt lgkmcnt(1)
    v_mfma_f32_32x32x16_bf16 v[0:15], v[56:59], a[24:27], v[0:15]
    s_waitcnt lgkmcnt(0)
    v_mfma_f32_32x32x16_bf16 v[0:15], v[60:63], a[28:31], v[0:15]
    s_nop 7
    s_nop 3
    v_max3_f32 v16, v16, v0, v1
    v_max3_f32 v16, v16, v2, v3
    v_max3_f32 v16, v16, v4, v5
    v_max3_f32 v16, v16, v6, v7
    v_max3_f32 v16, v16, v8, v9
    v_max3_f32 v16, v16, v10, v11
    v_max3_f32 v16, v16, v12, v13
    v_max3_f32 v16, v16, v14, v15
    ds_read_b128 v[32:35], v232 offset:20480
    ds_read_b128 v[36:39], v233 offset:20480
    ds_read_b128 v[40:43], v234 offset:20480
    ds_read_b128 v[44:47], v235 offset:20480
    ds_read_b128 v[48:51], v232 offset:28672
    ds_read_b128 v[52:55], v233 offset:28672
    ds_read_b128 v[56:59], v234 offset:28672
    ds_read_b128 v[60:63], v235 offset:28672
    s_waitcnt lgkmcnt(7)
    v_mfma_f32_32x32x16_bf16 v[0:15], v[32:35], a[0:3], 0
    s_waitcnt lgkmcnt(6)
    v_mfma_f32_32x32x16_bf16 v[0:15], v[36:39], a[4:7], v[0:15]
    s_waitcnt lgkmcnt(5)
    v_mfma_f32_32x32x16_bf16 v[0:15], v[40:43], a[8:11], v[0:15]
    s_waitcnt lgkmcnt(4)
    v_mfma_f32_32x32x16_bf16 v[0:15], v[44:47], a[12:15], v[0:15]
    s_waitcnt lgkmcnt(3)
    v_mfma_f32_32x32x16_bf16 v[0:15], v[48:51], a[16:19], v[0:15]
    s_waitcnt lgkmcnt(2)
    v_mfma_f32_32x32x16_bf16 v[0:15], v[52:55], a[20:23], v[0:15]
    s_waitcnt lgkmcnt(1)
    v_mfma_f32_32x32x16_bf16 v[0:15], v[56:59], a[24:27], v[0:15]
    s_waitcnt lgkmcnt(0)
    v_mfma_f32_32x32x16_bf16 v[0:15], v[60:63], a[28:31], v[0:15]
    s_nop 7
    s_nop 3
    v_max3_f32 v16, v16, v0, v1
    v_max3_f32 v16, v16, v2, v3
    v_max3_f32 v16, v16, v4, v5
    v_max3_f32 v16, v16, v6, v7
    v_max3_f32 v16, v16, v8, v9
    v_max3_f32 v16, v16, v10, v11
    v_max3_f32 v16, v16, v12, v13
    v_max3_f32 v16, v16, v14, v15
    v_mov_b32 v245, v16
    s_nop 1
    v_permlane32_swap_b32 v16, v245
    v_max_f32 v16, v16, v245
    v_sub_f32 v250, 0, v16
    s_waitcnt lgkmcnt(0)
    s_barrier
    s_add_u32 m0, s37, 0
    s_nop 0
    buffer_load_dwordx4 v242, s[12:15], s38 offen lds
    s_add_u32 m0, s37, 1024
    s_nop 0
    buffer_load_dwordx4 v243, s[12:15], s38 offen lds
    s_add_u32 m0, s37, 2048
    s_nop 0
    buffer_load_dwordx4 v242, s[12:15], s39 offen lds
    s_add_u32 m0, s37, 3072
    s_nop 0
    buffer_load_dwordx4 v243, s[12:15], s39 offen lds
    s_add_u32 m0, s35, 32768
    s_nop 0
    buffer_load_dwordx4 v242, s[16:19], s4 offen lds
    s_add_u32 m0, s35, 33792
    s_nop 0
    buffer_load_dwordx4 v243, s[16:19], s4 offen lds
    s_add_u32 m0, s35, 40960
    s_nop 0
    buffer_load_dwordx4 v242, s[16:19], s5 offen lds
    s_add_u32 m0, s35, 41984
    s_nop 0
    buffer_load_dwordx4 v243, s[16:19], s5 offen lds
    s_add_u32 m0, s35, 49152
    s_nop 0
    buffer_load_dwordx4 v242, s[16:19], s6 offen lds
    s_add_u32 m0, s35, 50176
    s_nop 0
    buffer_load_dwordx4 v243, s[16:19], s6 offen lds
    v_accvgpr_write_b32 a36, 0
    v_accvgpr_write_b32 a37, 0
    v_accvgpr_write_b32 a38, 0
    v_accvgpr_write_b32 a39, 0
    s_add_u32 m0, s35, 57344
    s_nop 0
    buffer_load_dwordx4 v242, s[16:19], s7 offen lds
    s_add_u32 m0, s35, 58368
    s_nop 0
    buffer_load_dwordx4 v243, s[16:19], s7 offen lds
    v_add_u32 v244, s37, v224
    v_add_u32 v245, s37, v225
    v_add_u32 v246, s37, v226
    v_add_u32 v247, s37, v227
    s_waitcnt vmcnt(8)
    ds_read_b128 v[192:195], v244 offset:0
    ds_read_b128 v[196:199], v245 offset:0
    ds_read_b128 v[200:203], v246 offset:0
    ds_read_b128 v[204:207], v247 offset:0
    s_waitcnt lgkmcnt(3)
    v_lshlrev_b32 v244, 16, v192
    v_and_b32 v245, 0xffff0000, v192
    v_lshlrev_b32 v246, 16, v193
    v_and_b32 v247, 0xffff0000, v193
    v_pk_mul_f32 v[244:245], v[244:245], s[100:101]
    v_pk_mul_f32 v[246:247], v[246:247], s[100:101]
    v_cvt_pk_bf16_f32 v192, v244, v245
    v_cvt_pk_bf16_f32 v193, v246, v247
    v_accvgpr_write_b32 a0, v192
    v_accvgpr_write_b32 a1, v193
    v_lshlrev_b32 v244, 16, v194
    v_and_b32 v245, 0xffff0000, v194
    v_lshlrev_b32 v246, 16, v195
    v_and_b32 v247, 0xffff0000, v195
    v_pk_mul_f32 v[244:245], v[244:245], s[100:101]
    v_pk_mul_f32 v[246:247], v[246:247], s[100:101]
    v_cvt_pk_bf16_f32 v194, v244, v245
    v_cvt_pk_bf16_f32 v195, v246, v247
    v_accvgpr_write_b32 a2, v194
    v_accvgpr_write_b32 a3, v195
    s_waitcnt vmcnt(6)
    s_barrier
    ds_read_b128 a[40:43], v224 offset:32768
    ds_read_b128 a[44:47], v224 offset:36864
    ds_read_b128 a[48:51], v225 offset:32768
    ds_read_b128 a[52:55], v225 offset:36864
    ds_read_b128 a[56:59], v226 offset:32768
    ds_read_b128 a[60:63], v226 offset:36864
    s_waitcnt lgkmcnt(4)
    v_mov_b32 v0, v250
    v_mov_b32 v1, v250
    v_mov_b32 v2, v250
    v_mov_b32 v3, v250
    v_mov_b32 v4, v250
    v_mov_b32 v5, v250
    v_mov_b32 v6, v250
    v_mov_b32 v7, v250
    v_mov_b32 v8, v250
    v_mov_b32 v9, v250
    v_mov_b32 v10, v250
    v_mov_b32 v11, v250
    v_mov_b32 v12, v250
    v_mov_b32 v13, v250
    v_mov_b32 v14, v250
    v_mov_b32 v15, v250
    s_nop 1
    v_mfma_f32_32x32x16_bf16 v[0:15], a[40:43], a[0:3], v[0:15]
    ds_read_b128 a[64:67], v227 offset:32768
    v_lshlrev_b32 v244, 16, v196
    v_and_b32 v245, 0xffff0000, v196
    v_lshlrev_b32 v246, 16, v197
    v_and_b32 v247, 0xffff0000, v197
    v_mul_f32 v244, s100, v244
    v_mul_f32 v245, s100, v245
    v_mul_f32 v246, s100, v246
    v_mul_f32 v247, s100, v247
    v_cvt_pk_bf16_f32 v196, v244, v245
    v_cvt_pk_bf16_f32 v197, v246, v247
    v_accvgpr_write_b32 a4, v196
    v_accvgpr_write_b32 a5, v197
    v_lshlrev_b32 v244, 16, v198
    v_and_b32 v245, 0xffff0000, v198
    s_add_u32 m0, s35, 65536
    v_mov_b32 v16, v250
    v_mov_b32 v17, v250
    v_mov_b32 v18, v250
    v_mov_b32 v19, v250
    v_mov_b32 v20, v250
    v_mov_b32 v21, v250
    v_mov_b32 v22, v250
    v_mov_b32 v23, v250
    v_mov_b32 v24, v250
    v_mov_b32 v25, v250
    v_mov_b32 v26, v250
    v_mov_b32 v27, v250
    v_mov_b32 v28, v250
    v_mov_b32 v29, v250
    v_mov_b32 v30, v250
    v_mov_b32 v31, v250
    s_nop 1
    v_mfma_f32_32x32x16_bf16 v[16:31], a[44:47], a[0:3], v[16:31]
    ds_read_b128 a[68:71], v227 offset:36864
    buffer_load_dwordx4 v242, s[16:19], s8 offen lds
    v_lshlrev_b32 v246, 16, v199
    v_and_b32 v247, 0xffff0000, v199
    v_mul_f32 v244, s100, v244
    v_mul_f32 v245, s100, v245
    v_mul_f32 v246, s100, v246
    v_mul_f32 v247, s100, v247
    v_cvt_pk_bf16_f32 v198, v244, v245
    v_cvt_pk_bf16_f32 v199, v246, v247
    v_accvgpr_write_b32 a6, v198
    v_accvgpr_write_b32 a7, v199
    s_waitcnt vmcnt(5)
    s_barrier
    s_waitcnt lgkmcnt(4)
    v_mfma_f32_32x32x16_bf16 v[0:15], a[48:51], a[4:7], v[0:15]
    ds_read_b128 a[40:43], v224 offset:40960
    v_lshlrev_b32 v244, 16, v200
    v_and_b32 v245, 0xffff0000, v200
    v_lshlrev_b32 v246, 16, v201
    v_and_b32 v247, 0xffff0000, v201
    v_mul_f32 v244, s100, v244
    v_mul_f32 v245, s100, v245
    v_mul_f32 v246, s100, v246
    v_mul_f32 v247, s100, v247
    v_cvt_pk_bf16_f32 v200, v244, v245
    v_cvt_pk_bf16_f32 v201, v246, v247
    v_accvgpr_write_b32 a8, v200
    v_accvgpr_write_b32 a9, v201
    v_lshlrev_b32 v244, 16, v202
    s_add_u32 m0, s35, 66560
    v_mfma_f32_32x32x16_bf16 v[16:31], a[52:55], a[4:7], v[16:31]
    ds_read_b128 a[44:47], v224 offset:45056
    buffer_load_dwordx4 v243, s[16:19], s8 offen lds
    v_and_b32 v245, 0xffff0000, v202
    v_lshlrev_b32 v246, 16, v203
    v_and_b32 v247, 0xffff0000, v203
    v_mul_f32 v244, s100, v244
    v_mul_f32 v245, s100, v245
    v_mul_f32 v246, s100, v246
    v_mul_f32 v247, s100, v247
    v_cvt_pk_bf16_f32 v202, v244, v245
    v_cvt_pk_bf16_f32 v203, v246, v247
    v_accvgpr_write_b32 a10, v202
    v_accvgpr_write_b32 a11, v203
    s_waitcnt lgkmcnt(4)
    s_nop 0
    v_mfma_f32_32x32x16_bf16 v[0:15], a[56:59], a[8:11], v[0:15]
    ds_read_b128 a[48:51], v225 offset:40960
    v_lshlrev_b32 v244, 16, v204
    v_and_b32 v245, 0xffff0000, v204
    v_lshlrev_b32 v246, 16, v205
    v_and_b32 v247, 0xffff0000, v205
    v_mul_f32 v244, s100, v244
    v_mul_f32 v245, s100, v245
    v_mul_f32 v246, s100, v246
    v_mul_f32 v247, s100, v247
    v_cvt_pk_bf16_f32 v204, v244, v245
    v_cvt_pk_bf16_f32 v205, v246, v247
    v_accvgpr_write_b32 a12, v204
    v_accvgpr_write_b32 a13, v205
    v_lshlrev_b32 v244, 16, v206
    s_add_u32 m0, s35, 73728
    v_mfma_f32_32x32x16_bf16 v[16:31], a[60:63], a[8:11], v[16:31]
    ds_read_b128 a[52:55], v225 offset:45056
    buffer_load_dwordx4 v242, s[16:19], s9 offen lds
    v_and_b32 v245, 0xffff0000, v206
    v_lshlrev_b32 v246, 16, v207
    v_and_b32 v247, 0xffff0000, v207
    v_mul_f32 v244, s100, v244
    v_mul_f32 v245, s100, v245
    v_mul_f32 v246, s100, v246
    v_mul_f32 v247, s100, v247
    v_cvt_pk_bf16_f32 v206, v244, v245
    v_cvt_pk_bf16_f32 v207, v246, v247
    v_accvgpr_write_b32 a14, v206
    v_accvgpr_write_b32 a15, v207
    s_waitcnt lgkmcnt(4)
    s_nop 0
    v_mfma_f32_32x32x16_bf16 v[0:15], a[64:67], a[12:15], v[0:15]
    ds_read_b128 a[56:59], v226 offset:40960
    s_add_u32 m0, s35, 74752
    v_mfma_f32_32x32x16_bf16 v[16:31], a[68:71], a[12:15], v[16:31]
    ds_read_b128 a[60:63], v226 offset:45056
    buffer_load_dwordx4 v243, s[16:19], s9 offen lds
    s_waitcnt lgkmcnt(4)
    v_mov_b32 v32, v250
    v_mov_b32 v33, v250
    v_mov_b32 v34, v250
    v_mov_b32 v35, v250
    v_mov_b32 v36, v250
    v_mov_b32 v37, v250
    v_mov_b32 v38, v250
    v_mov_b32 v39, v250
    v_mov_b32 v40, v250
    v_mov_b32 v41, v250
    v_mov_b32 v42, v250
    v_mov_b32 v43, v250
    v_mov_b32 v44, v250
    v_mov_b32 v45, v250
    v_mov_b32 v46, v250
    v_mov_b32 v47, v250
    s_nop 1
    v_mfma_f32_32x32x16_bf16 v[32:47], a[40:43], a[0:3], v[32:47]
    ds_read_b128 a[64:67], v227 offset:40960
    s_add_u32 m0, s37, 16256
    v_mov_b32 v48, v250
    v_mov_b32 v49, v250
    v_mov_b32 v50, v250
    v_mov_b32 v51, v250
    v_mov_b32 v52, v250
    v_mov_b32 v53, v250
    v_mov_b32 v54, v250
    v_mov_b32 v55, v250
    v_mov_b32 v56, v250
    v_mov_b32 v57, v250
    v_mov_b32 v58, v250
    v_mov_b32 v59, v250
    v_mov_b32 v60, v250
    v_mov_b32 v61, v250
    v_mov_b32 v62, v250
    v_mov_b32 v63, v250
    s_nop 1
    v_mfma_f32_32x32x16_bf16 v[48:63], a[44:47], a[0:3], v[48:63]
    ds_read_b128 a[68:71], v227 offset:45056
    buffer_load_dwordx4 v242, s[12:15], s38 offen offset:128 lds
    s_waitcnt vmcnt(7)
    s_barrier
    s_waitcnt lgkmcnt(4)
    v_mfma_f32_32x32x16_bf16 v[32:47], a[48:51], a[4:7], v[32:47]
    ds_read_b128 a[40:43], v224 offset:49152
    s_add_u32 m0, s37, 17280
    v_mfma_f32_32x32x16_bf16 v[48:63], a[52:55], a[4:7], v[48:63]
    ds_read_b128 a[44:47], v224 offset:53248
    buffer_load_dwordx4 v243, s[12:15], s38 offen offset:128 lds
    s_waitcnt lgkmcnt(4)
    v_mfma_f32_32x32x16_bf16 v[32:47], a[56:59], a[8:11], v[32:47]
    ds_read_b128 a[48:51], v225 offset:49152
    s_add_u32 m0, s37, 18304
    v_mfma_f32_32x32x16_bf16 v[48:63], a[60:63], a[8:11], v[48:63]
    ds_read_b128 a[52:55], v225 offset:53248
    buffer_load_dwordx4 v242, s[12:15], s39 offen offset:128 lds
    s_waitcnt lgkmcnt(4)
    v_mfma_f32_32x32x16_bf16 v[32:47], a[64:67], a[12:15], v[32:47]
    ds_read_b128 a[56:59], v226 offset:49152
    s_add_u32 m0, s37, 19328
    v_mfma_f32_32x32x16_bf16 v[48:63], a[68:71], a[12:15], v[48:63]
    ds_read_b128 a[60:63], v226 offset:53248
    buffer_load_dwordx4 v243, s[12:15], s39 offen offset:128 lds
    s_waitcnt lgkmcnt(4)
    v_mov_b32 v64, v250
    v_mov_b32 v65, v250
    v_mov_b32 v66, v250
    v_mov_b32 v67, v250
    v_mov_b32 v68, v250
    v_mov_b32 v69, v250
    v_mov_b32 v70, v250
    v_mov_b32 v71, v250
    v_mov_b32 v72, v250
    v_mov_b32 v73, v250
    v_mov_b32 v74, v250
    v_mov_b32 v75, v250
    v_mov_b32 v76, v250
    v_mov_b32 v77, v250
    v_mov_b32 v78, v250
    v_mov_b32 v79, v250
    s_nop 1
    v_mfma_f32_32x32x16_bf16 v[64:79], a[40:43], a[0:3], v[64:79]
    ds_read_b128 a[64:67], v227 offset:49152
    s_add_u32 m0, s35, 81792
    v_mov_b32 v80, v250
    v_mov_b32 v81, v250
    v_mov_b32 v82, v250
    v_mov_b32 v83, v250
    v_mov_b32 v84, v250
    v_mov_b32 v85, v250
    v_mov_b32 v86, v250
    v_mov_b32 v87, v250
    v_mov_b32 v88, v250
    v_mov_b32 v89, v250
    v_mov_b32 v90, v250
    v_mov_b32 v91, v250
    v_mov_b32 v92, v250
    v_mov_b32 v93, v250
    v_mov_b32 v94, v250
    v_mov_b32 v95, v250
    s_nop 1
    v_mfma_f32_32x32x16_bf16 v[80:95], a[44:47], a[0:3], v[80:95]
    ds_read_b128 a[68:71], v227 offset:53248
    buffer_load_dwordx4 v242, s[16:19], s4 offen offset:128 lds
    s_waitcnt vmcnt(9)
    s_barrier
    s_waitcnt lgkmcnt(4)
    v_mfma_f32_32x32x16_bf16 v[64:79], a[48:51], a[4:7], v[64:79]
    ds_read_b128 a[40:43], v224 offset:57344
    s_add_u32 m0, s35, 82816
    v_mfma_f32_32x32x16_bf16 v[80:95], a[52:55], a[4:7], v[80:95]
    ds_read_b128 a[44:47], v224 offset:61440
    buffer_load_dwordx4 v243, s[16:19], s4 offen offset:128 lds
    s_waitcnt lgkmcnt(4)
    v_mfma_f32_32x32x16_bf16 v[64:79], a[56:59], a[8:11], v[64:79]
    ds_read_b128 a[48:51], v225 offset:57344
    s_add_u32 m0, s35, 89984
    v_mfma_f32_32x32x16_bf16 v[80:95], a[60:63], a[8:11], v[80:95]
    ds_read_b128 a[52:55], v225 offset:61440
    buffer_load_dwordx4 v242, s[16:19], s5 offen offset:128 lds
    s_waitcnt lgkmcnt(4)
    v_mfma_f32_32x32x16_bf16 v[64:79], a[64:67], a[12:15], v[64:79]
    ds_read_b128 a[56:59], v226 offset:57344
    s_add_u32 m0, s35, 91008
    v_mfma_f32_32x32x16_bf16 v[80:95], a[68:71], a[12:15], v[80:95]
    ds_read_b128 a[60:63], v226 offset:61440
    buffer_load_dwordx4 v243, s[16:19], s5 offen offset:128 lds
    s_add_u32 m0, s35, 98176
    s_waitcnt lgkmcnt(4)
    v_mov_b32 v96, v250
    v_mov_b32 v97, v250
    v_mov_b32 v98, v250
    v_mov_b32 v99, v250
    v_mov_b32 v100, v250
    v_mov_b32 v101, v250
    v_mov_b32 v102, v250
    v_mov_b32 v103, v250
    v_mov_b32 v104, v250
    v_mov_b32 v105, v250
    v_mov_b32 v106, v250
    v_mov_b32 v107, v250
    v_mov_b32 v108, v250
    v_mov_b32 v109, v250
    v_mov_b32 v110, v250
    v_mov_b32 v111, v250
    s_nop 1
    v_mfma_f32_32x32x16_bf16 v[96:111], a[40:43], a[0:3], v[96:111]
    ds_read_b128 a[64:67], v227 offset:57344
    buffer_load_dwordx4 v242, s[16:19], s6 offen offset:128 lds
    s_add_u32 m0, s35, 99200
    v_mov_b32 v112, v250
    v_mov_b32 v113, v250
    v_mov_b32 v114, v250
    v_mov_b32 v115, v250
    v_mov_b32 v116, v250
    v_mov_b32 v117, v250
    v_mov_b32 v118, v250
    v_mov_b32 v119, v250
    v_mov_b32 v120, v250
    v_mov_b32 v121, v250
    v_mov_b32 v122, v250
    v_mov_b32 v123, v250
    v_mov_b32 v124, v250
    v_mov_b32 v125, v250
    v_mov_b32 v126, v250
    v_mov_b32 v127, v250
    s_nop 1
    v_mfma_f32_32x32x16_bf16 v[112:127], a[44:47], a[0:3], v[112:127]
    ds_read_b128 a[68:71], v227 offset:61440
    buffer_load_dwordx4 v243, s[16:19], s6 offen offset:128 lds
    s_waitcnt vmcnt(12)
    s_barrier
    s_add_u32 m0, s35, 106496
    s_waitcnt lgkmcnt(4)
    v_mfma_f32_32x32x16_bf16 v[96:111], a[48:51], a[4:7], v[96:111]
    ds_read_b128 a[40:43], v228 offset:0
    buffer_load_dwordx4 v248, s[20:23], s4 offen lds
    s_add_u32 m0, s35, 105472
    v_mfma_f32_32x32x16_bf16 v[112:127], a[52:55], a[4:7], v[112:127]
    ds_read_b128 a[44:47], v228 offset:4096
    buffer_load_dwordx4 v248, s[20:23], s4 offen offset:2048 lds
    s_add_u32 m0, s35, 114560
    s_waitcnt lgkmcnt(4)
    v_mfma_f32_32x32x16_bf16 v[96:111], a[56:59], a[8:11], v[96:111]
    ds_read_b128 a[48:51], v229 offset:0
    buffer_load_dwordx4 v242, s[16:19], s7 offen offset:128 lds
    s_add_u32 m0, s35, 115584
    v_mfma_f32_32x32x16_bf16 v[112:127], a[60:63], a[8:11], v[112:127]
    ds_read_b128 a[52:55], v229 offset:4096
    buffer_load_dwordx4 v243, s[16:19], s7 offen offset:128 lds
    s_add_u32 m0, s35, 122752
    s_waitcnt lgkmcnt(4)
    v_mfma_f32_32x32x16_bf16 v[96:111], a[64:67], a[12:15], v[96:111]
    ds_read_b128 a[56:59], v230 offset:0
    buffer_load_dwordx4 v248, s[20:23], s4 offen offset:128 lds
    s_add_u32 m0, s35, 121728
    v_mfma_f32_32x32x16_bf16 v[112:127], a[68:71], a[12:15], v[112:127]
    ds_read_b128 a[60:63], v230 offset:4096
    buffer_load_dwordx4 v248, s[20:23], s4 offen offset:2176 lds
    s_add_u32 m0, s35, 131072
    s_waitcnt lgkmcnt(4)
    v_mov_b32 v128, v250
    v_mov_b32 v129, v250
    v_mov_b32 v130, v250
    v_mov_b32 v131, v250
    v_mov_b32 v132, v250
    v_mov_b32 v133, v250
    v_mov_b32 v134, v250
    v_mov_b32 v135, v250
    v_mov_b32 v136, v250
    v_mov_b32 v137, v250
    v_mov_b32 v138, v250
    v_mov_b32 v139, v250
    v_mov_b32 v140, v250
    v_mov_b32 v141, v250
    v_mov_b32 v142, v250
    v_mov_b32 v143, v250
    s_nop 1
    v_mfma_f32_32x32x16_bf16 v[128:143], a[40:43], a[0:3], v[128:143]
    ds_read_b128 a[64:67], v231 offset:0
    buffer_load_dwordx4 v248, s[20:23], s5 offen lds
    s_add_u32 m0, s35, 130048
    v_mov_b32 v144, v250
    v_mov_b32 v145, v250
    v_mov_b32 v146, v250
    v_mov_b32 v147, v250
    v_mov_b32 v148, v250
    v_mov_b32 v149, v250
    v_mov_b32 v150, v250
    v_mov_b32 v151, v250
    v_mov_b32 v152, v250
    v_mov_b32 v153, v250
    v_mov_b32 v154, v250
    v_mov_b32 v155, v250
    v_mov_b32 v156, v250
    v_mov_b32 v157, v250
    v_mov_b32 v158, v250
    v_mov_b32 v159, v250
    s_nop 1
    v_mfma_f32_32x32x16_bf16 v[144:159], a[44:47], a[0:3], v[144:159]
    ds_read_b128 a[68:71], v231 offset:4096
    buffer_load_dwordx4 v248, s[20:23], s5 offen offset:2048 lds
    s_waitcnt vmcnt(12)
    s_barrier
    s_add_u32 m0, s35, 139136
    s_waitcnt lgkmcnt(4)
    v_mfma_f32_32x32x16_bf16 v[128:143], a[48:51], a[4:7], v[128:143]
    ds_read_b128 a[40:43], v228 offset:8192
    buffer_load_dwordx4 v248, s[20:23], s5 offen offset:128 lds
    s_add_u32 m0, s35, 138112
    v_mfma_f32_32x32x16_bf16 v[144:159], a[52:55], a[4:7], v[144:159]
    ds_read_b128 a[44:47], v228 offset:12288
    buffer_load_dwordx4 v248, s[20:23], s5 offen offset:2176 lds
    s_add_u32 m0, s35, 147328
    s_waitcnt lgkmcnt(4)
    v_mfma_f32_32x32x16_bf16 v[128:143], a[56:59], a[8:11], v[128:143]
    ds_read_b128 a[48:51], v229 offset:8192
    buffer_load_dwordx4 v242, s[16:19], s8 offen offset:128 lds
    s_add_u32 m0, s35, 148352
    v_mfma_f32_32x32x16_bf16 v[144:159], a[60:63], a[8:11], v[144:159]
    ds_read_b128 a[52:55], v229 offset:12288
    buffer_load_dwordx4 v243, s[16:19], s8 offen offset:128 lds
    v_add_u32 v244, s37, v224
    v_add_u32 v245, s37, v225
    v_add_u32 v246, s37, v226
    v_add_u32 v247, s37, v227
    s_waitcnt lgkmcnt(4)
    v_mfma_f32_32x32x16_bf16 v[128:143], a[64:67], a[12:15], v[128:143]
    ds_read_b128 a[56:59], v230 offset:8192
    s_waitcnt vmcnt(18)
    ds_read_b128 v[192:195], v244 offset:16384
    ds_read_b128 v[196:199], v245 offset:16384
    ds_read_b128 v[200:203], v246 offset:16384
    ds_read_b128 v[204:207], v247 offset:16384
    s_add_u32 m0, s35, 8192
    v_mfma_f32_32x32x16_bf16 v[144:159], a[68:71], a[12:15], v[144:159]
    ds_read_b128 a[60:63], v230 offset:12288
    buffer_load_dwordx4 v248, s[20:23], s6 offen lds
    s_waitcnt lgkmcnt(8)
    v_mov_b32 v160, v250
    v_mov_b32 v161, v250
    v_mov_b32 v162, v250
    v_mov_b32 v163, v250
    v_mov_b32 v164, v250
    v_mov_b32 v165, v250
    v_mov_b32 v166, v250
    v_mov_b32 v167, v250
    v_mov_b32 v168, v250
    v_mov_b32 v169, v250
    v_mov_b32 v170, v250
    v_mov_b32 v171, v250
    v_mov_b32 v172, v250
    v_mov_b32 v173, v250
    v_mov_b32 v174, v250
    v_mov_b32 v175, v250
    s_nop 1
    v_mfma_f32_32x32x16_bf16 v[160:175], a[40:43], a[0:3], v[160:175]
    ds_read_b128 a[64:67], v231 offset:8192
    s_waitcnt lgkmcnt(5)
    v_lshlrev_b32 v244, 16, v192
    v_and_b32 v245, 0xffff0000, v192
    v_lshlrev_b32 v246, 16, v193
    v_and_b32 v247, 0xffff0000, v193
    v_mul_f32 v244, s100, v244
    v_mul_f32 v245, s100, v245
    v_mul_f32 v246, s100, v246
    v_mul_f32 v247, s100, v247
    v_cvt_pk_bf16_f32 v192, v244, v245
    s_add_u32 m0, s35, 7168
    v_mov_b32 v176, v250
    v_mov_b32 v177, v250
    v_mov_b32 v178, v250
    v_mov_b32 v179, v250
    v_mov_b32 v180, v250
    v_mov_b32 v181, v250
    v_mov_b32 v182, v250
    v_mov_b32 v183, v250
    v_mov_b32 v184, v250
    v_mov_b32 v185, v250
    v_mov_b32 v186, v250
    v_mov_b32 v187, v250
    v_mov_b32 v188, v250
    v_mov_b32 v189, v250
    v_mov_b32 v190, v250
    v_mov_b32 v191, v250
    s_nop 1
    v_mfma_f32_32x32x16_bf16 v[176:191], a[44:47], a[0:3], v[176:191]
    ds_read_b128 a[68:71], v231 offset:12288
    buffer_load_dwordx4 v248, s[20:23], s6 offen offset:2048 lds
    v_cvt_pk_bf16_f32 v193, v246, v247
    v_accvgpr_write_b32 a16, v192
    v_accvgpr_write_b32 a17, v193
    v_lshlrev_b32 v244, 16, v194
    v_and_b32 v245, 0xffff0000, v194
    v_lshlrev_b32 v246, 16, v195
    v_mfma_f32_32x32x16_bf16 v[160:175], a[48:51], a[4:7], v[160:175]
    ds_read_b128 a[40:43], v228 offset:16384
    v_and_b32 v247, 0xffff0000, v195
    v_mul_f32 v244, s100, v244
    v_mul_f32 v245, s100, v245
    v_mul_f32 v246, s100, v246
    v_mul_f32 v247, s100, v247
    v_cvt_pk_bf16_f32 v194, v244, v245
    v_cvt_pk_bf16_f32 v195, v246, v247
    v_accvgpr_write_b32 a18, v194
    v_accvgpr_write_b32 a19, v195
    s_add_u32 m0, s35, 32640
    v_mfma_f32_32x32x16_bf16 v[176:191], a[52:55], a[4:7], v[176:191]
    ds_read_b128 a[44:47], v228 offset:20480
    buffer_load_dwordx4 v248, s[20:23], s6 offen offset:128 lds
    s_waitcnt lgkmcnt(7)
    v_lshlrev_b32 v244, 16, v196
    v_and_b32 v245, 0xffff0000, v196
    v_lshlrev_b32 v246, 16, v197
    v_and_b32 v247, 0xffff0000, v197
    v_mul_f32 v244, s100, v244
    v_mul_f32 v245, s100, v245
    s_waitcnt lgkmcnt(4)
    v_mfma_f32_32x32x16_bf16 v[160:175], a[56:59], a[8:11], v[160:175]
    ds_read_b128 a[48:51], v229 offset:16384
    v_mul_f32 v246, s100, v246
    v_mul_f32 v247, s100, v247
    v_cvt_pk_bf16_f32 v196, v244, v245
    v_cvt_pk_bf16_f32 v197, v246, v247
    v_accvgpr_write_b32 a20, v196
    v_accvgpr_write_b32 a21, v197
    v_lshlrev_b32 v244, 16, v198
    v_and_b32 v245, 0xffff0000, v198
    v_lshlrev_b32 v246, 16, v199
    s_add_u32 m0, s35, 31616
    v_mfma_f32_32x32x16_bf16 v[176:191], a[60:63], a[8:11], v[176:191]
    ds_read_b128 a[52:55], v229 offset:20480
    buffer_load_dwordx4 v248, s[20:23], s6 offen offset:2176 lds
    v_and_b32 v247, 0xffff0000, v199
    v_mul_f32 v244, s100, v244
    v_mul_f32 v245, s100, v245
    v_mul_f32 v246, s100, v246
    s_waitcnt vmcnt(18)
    s_barrier
    s_waitcnt lgkmcnt(4)
    v_mfma_f32_32x32x16_bf16 v[160:175], a[64:67], a[12:15], v[160:175]
    ds_read_b128 a[56:59], v230 offset:16384
    v_mul_f32 v247, s100, v247
    v_cvt_pk_bf16_f32 v198, v244, v245
    v_cvt_pk_bf16_f32 v199, v246, v247
    v_accvgpr_write_b32 a22, v198
    v_accvgpr_write_b32 a23, v199
    v_lshlrev_b32 v244, 16, v200
    v_and_b32 v245, 0xffff0000, v200
    v_lshlrev_b32 v246, 16, v201
    v_and_b32 v247, 0xffff0000, v201
    s_add_u32 m0, s35, 40960
    v_mfma_f32_32x32x16_bf16 v[176:191], a[68:71], a[12:15], v[176:191]
    ds_read_b128 a[60:63], v230 offset:20480
    buffer_load_dwordx4 v248, s[20:23], s7 offen lds
    v_mul_f32 v244, s100, v244
    v_mul_f32 v245, s100, v245
    v_mul_f32 v246, s100, v246
    v_mul_f32 v247, s100, v247
    v_cvt_pk_bf16_f32 v200, v244, v245
    v_cvt_pk_bf16_f32 v201, v246, v247
    s_waitcnt lgkmcnt(4)
    v_mfma_f32_32x32x16_bf16 v[0:15], a[40:43], a[16:19], v[0:15]
    ds_read_b128 a[64:67], v231 offset:16384
    v_accvgpr_write_b32 a24, v200
    v_accvgpr_write_b32 a25, v201
    v_lshlrev_b32 v244, 16, v202
    v_and_b32 v245, 0xffff0000, v202
    v_lshlrev_b32 v246, 16, v203
    v_and_b32 v247, 0xffff0000, v203
    v_mul_f32 v244, s100, v244
    v_mul_f32 v245, s100, v245
    v_mul_f32 v246, s100, v246
    s_add_u32 m0, s35, 39936
    v_mfma_f32_32x32x16_bf16 v[16:31], a[44:47], a[16:19], v[16:31]
    ds_read_b128 a[68:71], v231 offset:20480
    buffer_load_dwordx4 v248, s[20:23], s7 offen offset:2048 lds
    v_mul_f32 v247, s100, v247
    v_cvt_pk_bf16_f32 v202, v244, v245
    v_cvt_pk_bf16_f32 v203, v246, v247
    v_accvgpr_write_b32 a26, v202
    v_accvgpr_write_b32 a27, v203
    v_lshlrev_b32 v244, 16, v204
    s_waitcnt lgkmcnt(4)
    v_mfma_f32_32x32x16_bf16 v[0:15], a[48:51], a[20:23], v[0:15]
    ds_read_b128 a[40:43], v228 offset:24576
    v_and_b32 v245, 0xffff0000, v204
    v_lshlrev_b32 v246, 16, v205
    v_and_b32 v247, 0xffff0000, v205
    v_mul_f32 v244, s100, v244
    v_mul_f32 v245, s100, v245
    v_mul_f32 v246, s100, v246
    v_mul_f32 v247, s100, v247
    v_cvt_pk_bf16_f32 v204, v244, v245
    v_cvt_pk_bf16_f32 v205, v246, v247
    s_add_u32 m0, s35, 49024
    v_mfma_f32_32x32x16_bf16 v[16:31], a[52:55], a[20:23], v[16:31]
    ds_read_b128 a[44:47], v228 offset:28672
    buffer_load_dwordx4 v248, s[20:23], s7 offen offset:128 lds
    v_accvgpr_write_b32 a28, v204
    v_accvgpr_write_b32 a29, v205
    v_lshlrev_b32 v244, 16, v206
    v_and_b32 v245, 0xffff0000, v206
    v_lshlrev_b32 v246, 16, v207
    v_and_b32 v247, 0xffff0000, v207
    s_waitcnt lgkmcnt(4)
    v_mfma_f32_32x32x16_bf16 v[0:15], a[56:59], a[24:27], v[0:15]
    ds_read_b128 a[48:51], v229 offset:24576
    v_mul_f32 v244, s100, v244
    v_mul_f32 v245, s100, v245
    v_mul_f32 v246, s100, v246
    v_mul_f32 v247, s100, v247
    v_cvt_pk_bf16_f32 v206, v244, v245
    v_cvt_pk_bf16_f32 v207, v246, v247
    v_accvgpr_write_b32 a30, v206
    v_accvgpr_write_b32 a31, v207
    s_add_u32 m0, s35, 48000
    v_mfma_f32_32x32x16_bf16 v[16:31], a[60:63], a[24:27], v[16:31]
    ds_read_b128 a[52:55], v229 offset:28672
    buffer_load_dwordx4 v248, s[20:23], s7 offen offset:2176 lds
    s_waitcnt lgkmcnt(4)
    v_mfma_f32_32x32x16_bf16 v[0:15], a[64:67], a[28:31], v[0:15]
    ds_read_b128 a[56:59], v230 offset:24576
    s_add_u32 m0, s35, 57216
    v_mfma_f32_32x32x16_bf16 v[16:31], a[68:71], a[28:31], v[16:31]
    ds_read_b128 a[60:63], v230 offset:28672
    buffer_load_dwordx4 v242, s[16:19], s9 offen offset:128 lds
    s_waitcnt lgkmcnt(4)
    v_mfma_f32_32x32x16_bf16 v[32:47], a[40:43], a[16:19], v[32:47]
    ds_read_b128 a[64:67], v231 offset:24576
    s_add_u32 m0, s35, 58240
    v_mfma_f32_32x32x16_bf16 v[48:63], a[44:47], a[16:19], v[48:63]
    ds_read_b128 a[68:71], v231 offset:28672
    buffer_load_dwordx4 v243, s[16:19], s9 offen offset:128 lds
    s_waitcnt vmcnt(18)
    s_barrier
    s_waitcnt lgkmcnt(4)
    v_mfma_f32_32x32x16_bf16 v[32:47], a[48:51], a[20:23], v[32:47]
    ds_read_b128 a[40:43], v228 offset:32768
    v_exp_f32 v0, v0
    v_exp_f32 v1, v1
    v_exp_f32 v2, v2
    s_add_u32 m0, s35, 16384
    v_mfma_f32_32x32x16_bf16 v[48:63], a[52:55], a[20:23], v[48:63]
    ds_read_b128 a[44:47], v228 offset:36864
    buffer_load_dwordx4 v248, s[20:23], s8 offen lds
    v_exp_f32 v3, v3
    v_cvt_pk_bf16_f32 v0, v0, v1
    s_waitcnt lgkmcnt(4)
    v_mfma_f32_32x32x16_bf16 v[32:47], a[56:59], a[24:27], v[32:47]
    ds_read_b128 a[48:51], v229 offset:32768
    v_exp_f32 v4, v4
    v_exp_f32 v5, v5
    v_cvt_pk_bf16_f32 v1, v2, v3
    s_add_u32 m0, s35, 15360
    v_mfma_f32_32x32x16_bf16 v[48:63], a[60:63], a[24:27], v[48:63]
    ds_read_b64_tr_b16 a[52:53], v238 offset:40960
    ds_read_b64_tr_b16 a[54:55], v238 offset:41984
    buffer_load_dwordx4 v248, s[20:23], s8 offen offset:2048 lds
    v_exp_f32 v6, v6
    s_waitcnt lgkmcnt(5)
    v_mfma_f32_32x32x16_bf16 v[32:47], a[64:67], a[28:31], v[32:47]
    ds_read_b64_tr_b16 a[56:57], v239 offset:40960
    ds_read_b64_tr_b16 a[58:59], v239 offset:41984
    v_exp_f32 v7, v7
    v_cvt_pk_bf16_f32 v2, v4, v5
    v_exp_f32 v8, v8
    s_add_u32 m0, s35, 24448
    v_mfma_f32_32x32x16_bf16 v[48:63], a[68:71], a[28:31], v[48:63]
    ds_read_b64_tr_b16 a[60:61], v238 offset:43008
    ds_read_b64_tr_b16 a[62:63], v238 offset:44032
    buffer_load_dwordx4 v248, s[20:23], s8 offen offset:128 lds
    v_exp_f32 v9, v9
    s_waitcnt lgkmcnt(7)
    v_mfma_f32_32x32x16_bf16 v[64:79], a[40:43], a[16:19], v[64:79]
    ds_read_b64_tr_b16 a[64:65], v239 offset:43008
    ds_read_b64_tr_b16 a[66:67], v239 offset:44032
    v_cvt_pk_bf16_f32 v3, v6, v7
    v_exp_f32 v10, v10
    v_exp_f32 v11, v11
    s_add_u32 m0, s35, 23424
    v_mfma_f32_32x32x16_bf16 v[80:95], a[44:47], a[16:19], v[80:95]
    ds_read_b128 a[68:71], v230 offset:32768
    buffer_load_dwordx4 v248, s[20:23], s8 offen offset:2176 lds
    v_cvt_pk_bf16_f32 v4, v8, v9
    v_exp_f32 v12, v12
    s_waitcnt lgkmcnt(7)
    v_mfma_f32_32x32x16_bf16 v[64:79], a[48:51], a[20:23], v[64:79]
    ds_read_b128 a[40:43], v229 offset:36864
    v_exp_f32 v13, v13
    v_cvt_pk_bf16_f32 v5, v10, v11
    v_exp_f32 v14, v14
    s_add_u32 m0, s35, 0
    v_mfma_f32_32x32x16_bf16 v[192:207], a[52:55], v[0:3], 0
    ds_read_b128 a[44:47], v231 offset:32768
    buffer_load_dwordx4 v242, s[16:19], s10 offen lds
    v_exp_f32 v15, v15
    v_cvt_pk_bf16_f32 v6, v12, v13
    s_waitcnt lgkmcnt(5)
    v_mfma_f32_32x32x16_bf16 v[208:223], a[56:59], v[0:3], 0
    ds_read_b128 a[48:51], v230 offset:36864
    v_cvt_pk_bf16_f32 v7, v14, v15
    s_add_u32 m0, s35, 1024
    s_nop 0
    v_mfma_f32_32x32x16_bf16 v[192:207], a[60:63], v[4:7], v[192:207]
    ds_read_b128 a[52:55], v228 offset:49152
    buffer_load_dwordx4 v243, s[16:19], s10 offen lds
    v_exp_f32 v16, v16
    s_waitcnt vmcnt(22)
    s_barrier
    s_waitcnt lgkmcnt(4)
    v_mfma_f32_32x32x16_bf16 v[208:223], a[64:67], v[4:7], v[208:223]
    ds_read_b128 a[56:59], v231 offset:36864
    v_exp_f32 v17, v17
    v_exp_f32 v18, v18
    v_smfmac_f32_16x16x64_bf16 a[36:39], a[32:35], v[0:7], v249
    v_exp_f32 v19, v19
    v_cvt_pk_bf16_f32 v8, v16, v17
    s_add_u32 m0, s35, 65408
    v_mfma_f32_32x32x16_bf16 v[64:79], a[68:71], a[24:27], v[64:79]
    ds_read_b128 a[60:63], v229 offset:49152
    buffer_load_dwordx4 v242, s[16:19], s10 offen offset:128 lds
    v_exp_f32 v20, v20
    v_exp_f32 v21, v21
    s_waitcnt lgkmcnt(4)
    v_mfma_f32_32x32x16_bf16 v[80:95], a[40:43], a[20:23], v[80:95]
    ds_read_b64_tr_b16 a[64:65], v238 offset:45056
    ds_read_b64_tr_b16 a[66:67], v238 offset:46080
    v_cvt_pk_bf16_f32 v9, v18, v19
    v_exp_f32 v22, v22
    v_exp_f32 v23, v23
    s_add_u32 m0, s35, 66432
    v_mfma_f32_32x32x16_bf16 v[64:79], a[44:47], a[28:31], v[64:79]
    ds_read_b64_tr_b16 a[68:69], v239 offset:45056
    ds_read_b64_tr_b16 a[70:71], v239 offset:46080
    buffer_load_dwordx4 v243, s[16:19], s10 offen offset:128 lds
    v_cvt_pk_bf16_f32 v10, v20, v21
    v_exp_f32 v24, v24
    s_waitcnt lgkmcnt(6)
    v_mfma_f32_32x32x16_bf16 v[80:95], a[48:51], a[24:27], v[80:95]
    ds_read_b64_tr_b16 a[40:41], v238 offset:57344
    ds_read_b64_tr_b16 a[42:43], v238 offset:58368
    v_exp_f32 v25, v25
    v_cvt_pk_bf16_f32 v11, v22, v23
    v_exp_f32 v26, v26
    s_add_u32 m0, s35, 73728
    v_mfma_f32_32x32x16_bf16 v[96:111], a[52:55], a[16:19], v[96:111]
    ds_read_b64_tr_b16 a[44:45], v238 offset:47104
    ds_read_b64_tr_b16 a[46:47], v238 offset:48128
    buffer_load_dwordx4 v248, s[20:23], s9 offen lds
    v_exp_f32 v27, v27
    s_waitcnt lgkmcnt(8)
    v_mfma_f32_32x32x16_bf16 v[80:95], a[56:59], a[28:31], v[80:95]
    ds_read_b64_tr_b16 a[48:49], v238 offset:59392
    ds_read_b64_tr_b16 a[50:51], v238 offset:60416
    v_cvt_pk_bf16_f32 v12, v24, v25
    v_exp_f32 v28, v28
    v_exp_f32 v29, v29
    s_add_u32 m0, s35, 72704
    v_mfma_f32_32x32x16_bf16 v[96:111], a[60:63], a[20:23], v[96:111]
    ds_read_b64_tr_b16 a[52:53], v239 offset:47104
    ds_read_b64_tr_b16 a[54:55], v239 offset:48128
    buffer_load_dwordx4 v248, s[20:23], s9 offen offset:2048 lds
    v_cvt_pk_bf16_f32 v13, v26, v27
    v_exp_f32 v30, v30
    s_waitcnt lgkmcnt(8)
    v_mfma_f32_32x32x16_bf16 v[192:207], a[64:67], v[8:11], v[192:207]
    ds_read_b64_tr_b16 a[56:57], v238 offset:61440
    ds_read_b64_tr_b16 a[58:59], v238 offset:62464
    v_exp_f32 v31, v31
    v_cvt_pk_bf16_f32 v14, v28, v29
    v_cvt_pk_bf16_f32 v15, v30, v31
    s_add_u32 m0, s35, 81792
    v_mfma_f32_32x32x16_bf16 v[208:223], a[68:71], v[8:11], v[208:223]
    ds_read_b128 a[60:63], v230 offset:49152
    buffer_load_dwordx4 v248, s[20:23], s9 offen offset:128 lds
    s_waitcnt lgkmcnt(7)
    v_mfma_f32_32x32x16_bf16 v[16:31], a[40:43], v[0:3], 0
    ds_read_b64_tr_b16 a[64:65], v238 offset:63488
    ds_read_b64_tr_b16 a[66:67], v238 offset:64512
    v_exp_f32 v32, v32
    v_exp_f32 v33, v33
    s_add_u32 m0, s35, 80768
    v_mfma_f32_32x32x16_bf16 v[192:207], a[44:47], v[12:15], v[192:207]
    ds_read_b128 a[68:71], v231 offset:49152
    buffer_load_dwordx4 v248, s[20:23], s9 offen offset:2176 lds
    v_exp_f32 v34, v34
    v_smfmac_f32_16x16x64_bf16 a[36:39], a[32:35], v[8:15], v249
    v_exp_f32 v35, v35
    s_waitcnt vmcnt(20)
    s_barrier
    s_waitcnt lgkmcnt(6)
    v_mfma_f32_32x32x16_bf16 v[16:31], a[48:51], v[4:7], v[16:31]
    ds_read_b128 a[40:43], v228 offset:53248
    v_cvt_pk_bf16_f32 v32, v32, v33
    v_exp_f32 v36, v36
    v_exp_f32 v37, v37
    s_add_u32 m0, s35, 90112
    v_mfma_f32_32x32x16_bf16 v[208:223], a[52:55], v[12:15], v[208:223]
    ds_read_b64_tr_b16 a[44:45], v240 offset:0
    ds_read_b64_tr_b16 a[46:47], v240 offset:1024
    buffer_load_dwordx4 v242, s[16:19], s11 offen lds
    v_cvt_pk_bf16_f32 v33, v34, v35
    v_exp_f32 v38, v38
    s_waitcnt lgkmcnt(6)
    v_mfma_f32_32x32x16_bf16 v[16:31], a[56:59], v[8:11], v[16:31]
    ds_read_b64_tr_b16 a[48:49], v241 offset:0
    ds_read_b64_tr_b16 a[50:51], v241 offset:1024
    v_exp_f32 v39, v39
    v_cvt_pk_bf16_f32 v34, v36, v37
    v_exp_f32 v40, v40
    s_add_u32 m0, s35, 91136
    v_mfma_f32_32x32x16_bf16 v[96:111], a[60:63], a[24:27], v[96:111]
    ds_read_b64_tr_b16 a[52:53], v240 offset:8192
    ds_read_b64_tr_b16 a[54:55], v240 offset:9216
    buffer_load_dwordx4 v243, s[16:19], s11 offen lds
    v_exp_f32 v41, v41
    s_waitcnt lgkmcnt(7)
    v_mfma_f32_32x32x16_bf16 v[16:31], a[64:67], v[12:15], v[16:31]
    ds_read_b64_tr_b16 a[56:57], v240 offset:2048
    ds_read_b64_tr_b16 a[58:59], v240 offset:3072
    v_cvt_pk_bf16_f32 v35, v38, v39
    v_exp_f32 v42, v42
    v_exp_f32 v43, v43
    s_add_u32 m0, s35, 98176
    v_mfma_f32_32x32x16_bf16 v[96:111], a[68:71], a[28:31], v[96:111]
    ds_read_b64_tr_b16 a[60:61], v241 offset:2048
    ds_read_b64_tr_b16 a[62:63], v241 offset:3072
    buffer_load_dwordx4 v242, s[16:19], s11 offen offset:128 lds
    v_cvt_pk_bf16_f32 v36, v40, v41
    v_exp_f32 v44, v44
    s_waitcnt lgkmcnt(8)
    v_mfma_f32_32x32x16_bf16 v[112:127], a[40:43], a[16:19], v[112:127]
    ds_read_b64_tr_b16 a[64:65], v240 offset:10240
    ds_read_b64_tr_b16 a[66:67], v240 offset:11264
    v_exp_f32 v45, v45
    v_cvt_pk_bf16_f32 v37, v42, v43
    v_exp_f32 v46, v46
    s_add_u32 m0, s35, 99200
    v_mfma_f32_32x32x16_bf16 v[192:207], a[44:47], v[32:35], v[192:207]
    ds_read_b128 a[68:71], v229 offset:53248
    buffer_load_dwordx4 v243, s[16:19], s11 offen offset:128 lds
    v_exp_f32 v47, v47
    v_cvt_pk_bf16_f32 v38, v44, v45
    s_waitcnt lgkmcnt(7)
    v_mfma_f32_32x32x16_bf16 v[208:223], a[48:51], v[32:35], v[208:223]
    ds_read_b128 a[40:43], v232 offset:16384
    v_cvt_pk_bf16_f32 v39, v46, v47
    v_mfma_f32_32x32x16_bf16 v[16:31], a[52:55], v[32:35], v[16:31]
    ds_read_b128 a[44:47], v230 offset:53248
    v_exp_f32 v48, v48
    v_exp_f32 v49, v49
    s_waitcnt lgkmcnt(5)
    v_mfma_f32_32x32x16_bf16 v[192:207], a[56:59], v[36:39], v[192:207]
    ds_read_b128 a[48:51], v233 offset:16384
    v_exp_f32 v50, v50
    v_exp_f32 v51, v51
    v_smfmac_f32_16x16x64_bf16 a[36:39], a[32:35], v[32:39], v249
    v_cvt_pk_bf16_f32 v40, v48, v49
    v_exp_f32 v52, v52
    v_mfma_f32_32x32x16_bf16 v[208:223], a[60:63], v[36:39], v[208:223]
    ds_read_b128 a[52:55], v231 offset:53248
    v_exp_f32 v53, v53
    v_cvt_pk_bf16_f32 v41, v50, v51
    s_waitcnt vmcnt(18)
    s_barrier
    s_add_u32 m0, s35, 106496
    s_waitcnt lgkmcnt(4)
    v_mfma_f32_32x32x16_bf16 v[16:31], a[64:67], v[36:39], v[16:31]
    ds_read_b64_tr_b16 a[56:57], v240 offset:4096
    ds_read_b64_tr_b16 a[58:59], v240 offset:5120
    buffer_load_dwordx4 v248, s[20:23], s10 offen lds
    v_exp_f32 v54, v54
    v_mfma_f32_32x32x16_bf16 v[112:127], a[68:71], a[20:23], v[112:127]
    ds_read_b64_tr_b16 a[60:61], v241 offset:4096
    ds_read_b64_tr_b16 a[62:63], v241 offset:5120
    v_exp_f32 v55, v55
    v_cvt_pk_bf16_f32 v42, v52, v53
    s_add_u32 m0, s35, 105472
    s_waitcnt lgkmcnt(6)
    v_mfma_f32_32x32x16_bf16 v[128:143], a[40:43], a[16:19], v[128:143]
    ds_read_b64_tr_b16 a[64:65], v239 offset:57344
    ds_read_b64_tr_b16 a[66:67], v239 offset:58368
    buffer_load_dwordx4 v248, s[20:23], s10 offen offset:2048 lds
    v_exp_f32 v56, v56
    v_mfma_f32_32x32x16_bf16 v[112:127], a[44:47], a[24:27], v[112:127]
    ds_read_b64_tr_b16 a[68:69], v240 offset:12288
    ds_read_b64_tr_b16 a[70:71], v240 offset:13312
    v_exp_f32 v57, v57
    v_cvt_pk_bf16_f32 v43, v54, v55
    s_waitcnt lgkmcnt(8)
    v_mfma_f32_32x32x16_bf16 v[128:143], a[48:51], a[20:23], v[128:143]
    ds_read_b64_tr_b16 a[40:41], v239 offset:59392
    ds_read_b64_tr_b16 a[42:43], v239 offset:60416
    v_exp_f32 v58, v58
    v_exp_f32 v59, v59
    v_mfma_f32_32x32x16_bf16 v[112:127], a[52:55], a[28:31], v[112:127]
    ds_read_b64_tr_b16 a[44:45], v240 offset:6144
    ds_read_b64_tr_b16 a[46:47], v240 offset:7168
    v_cvt_pk_bf16_f32 v44, v56, v57
    v_exp_f32 v60, v60
    s_waitcnt lgkmcnt(8)
    v_mfma_f32_32x32x16_bf16 v[192:207], a[56:59], v[40:43], v[192:207]
    ds_read_b64_tr_b16 a[48:49], v239 offset:61440
    ds_read_b64_tr_b16 a[50:51], v239 offset:62464
    v_exp_f32 v61, v61
    v_cvt_pk_bf16_f32 v45, v58, v59
    v_exp_f32 v62, v62
    v_mfma_f32_32x32x16_bf16 v[208:223], a[60:63], v[40:43], v[208:223]
    ds_read_b64_tr_b16 a[52:53], v241 offset:6144
    ds_read_b64_tr_b16 a[54:55], v241 offset:7168
    v_exp_f32 v63, v63
    v_cvt_pk_bf16_f32 v46, v60, v61
    v_cvt_pk_bf16_f32 v47, v62, v63
    s_waitcnt lgkmcnt(8)
    v_mfma_f32_32x32x16_bf16 v[48:63], a[64:67], v[0:3], 0
    ds_read_b64_tr_b16 a[56:57], v239 offset:63488
    ds_read_b64_tr_b16 a[58:59], v239 offset:64512
    v_exp_f32 v64, v64
    v_exp_f32 v65, v65
    v_mfma_f32_32x32x16_bf16 v[16:31], a[68:71], v[40:43], v[16:31]
    ds_read_b64_tr_b16 a[60:61], v240 offset:14336
    ds_read_b64_tr_b16 a[62:63], v240 offset:15360
    v_exp_f32 v66, v66
    v_smfmac_f32_16x16x64_bf16 a[36:39], a[32:35], v[40:47], v249
    v_exp_f32 v67, v67
    v_cvt_pk_bf16_f32 v64, v64, v65
    s_waitcnt lgkmcnt(8)
    v_mfma_f32_32x32x16_bf16 v[48:63], a[40:43], v[4:7], v[48:63]
    ds_read_b64_tr_b16 a[64:65], v241 offset:8192
    ds_read_b64_tr_b16 a[66:67], v241 offset:9216
    v_exp_f32 v68, v68
    v_exp_f32 v69, v69
    v_cvt_pk_bf16_f32 v65, v66, v67
    v_mfma_f32_32x32x16_bf16 v[192:207], a[44:47], v[44:47], v[192:207]
    ds_read_b64_tr_b16 a[68:69], v236 offset:8192
    ds_read_b64_tr_b16 a[70:71], v236 offset:9216
    v_exp_f32 v70, v70
    s_waitcnt vmcnt(14)
    s_barrier
    s_add_u32 m0, s35, 114688
    s_waitcnt lgkmcnt(8)
    v_mfma_f32_32x32x16_bf16 v[48:63], a[48:51], v[8:11], v[48:63]
    ds_read_b64_tr_b16 a[40:41], v241 offset:10240
    ds_read_b64_tr_b16 a[42:43], v241 offset:11264
    buffer_load_dwordx4 v248, s[20:23], s11 offen lds
    v_exp_f32 v71, v71
    v_cvt_pk_bf16_f32 v66, v68, v69
    v_mfma_f32_32x32x16_bf16 v[208:223], a[52:55], v[44:47], v[208:223]
    ds_read_b64_tr_b16 a[44:45], v237 offset:8192
    ds_read_b64_tr_b16 a[46:47], v237 offset:9216
    v_exp_f32 v72, v72
    v_exp_f32 v73, v73
    s_add_u32 m0, s35, 113664
    s_waitcnt lgkmcnt(8)
    v_mfma_f32_32x32x16_bf16 v[48:63], a[56:59], v[12:15], v[48:63]
    ds_read_b64_tr_b16 a[48:49], v241 offset:12288
    ds_read_b64_tr_b16 a[50:51], v241 offset:13312
    buffer_load_dwordx4 v248, s[20:23], s11 offen offset:2048 lds
    v_cvt_pk_bf16_f32 v67, v70, v71
    v_exp_f32 v74, v74
    v_mfma_f32_32x32x16_bf16 v[16:31], a[60:63], v[44:47], v[16:31]
    ds_read_b64_tr_b16 a[52:53], v236 offset:32768
    ds_read_b64_tr_b16 a[54:55], v236 offset:33792
    v_exp_f32 v75, v75
    v_cvt_pk_bf16_f32 v68, v72, v73
    s_waitcnt lgkmcnt(8)
    v_mfma_f32_32x32x16_bf16 v[48:63], a[64:67], v[32:35], v[48:63]
    ds_read_b64_tr_b16 a[56:57], v241 offset:14336
    ds_read_b64_tr_b16 a[58:59], v241 offset:15360
    v_exp_f32 v76, v76
    v_exp_f32 v77, v77
    v_cvt_pk_bf16_f32 v69, v74, v75
    v_mfma_f32_32x32x16_bf16 v[192:207], a[68:71], v[64:67], v[192:207]
    ds_read_b64_tr_b16 a[60:61], v236 offset:10240
    ds_read_b64_tr_b16 a[62:63], v236 offset:11264
    v_exp_f32 v78, v78
    v_exp_f32 v79, v79
    s_waitcnt lgkmcnt(8)
    v_mfma_f32_32x32x16_bf16 v[48:63], a[40:43], v[36:39], v[48:63]
    ds_read_b64_tr_b16 a[64:65], v237 offset:32768
    ds_read_b64_tr_b16 a[66:67], v237 offset:33792
    v_cvt_pk_bf16_f32 v70, v76, v77
    v_cvt_pk_bf16_f32 v71, v78, v79
    v_mfma_f32_32x32x16_bf16 v[208:223], a[44:47], v[64:67], v[208:223]
    ds_read_b64_tr_b16 a[68:69], v237 offset:10240
    ds_read_b64_tr_b16 a[70:71], v237 offset:11264
    v_exp_f32 v80, v80
    v_exp_f32 v81, v81
    s_waitcnt lgkmcnt(8)
    v_mfma_f32_32x32x16_bf16 v[48:63], a[48:51], v[40:43], v[48:63]
    ds_read_b64_tr_b16 a[40:41], v236 offset:34816
    ds_read_b64_tr_b16 a[42:43], v236 offset:35840
    v_exp_f32 v82, v82
    v_exp_f32 v83, v83
    v_smfmac_f32_16x16x64_bf16 a[36:39], a[32:35], v[64:71], v249
    v_cvt_pk_bf16_f32 v72, v80, v81
    v_exp_f32 v84, v84
    v_mfma_f32_32x32x16_bf16 v[16:31], a[52:55], v[64:67], v[16:31]
    ds_read_b64_tr_b16 a[44:45], v237 offset:34816
    ds_read_b64_tr_b16 a[46:47], v237 offset:35840
    v_exp_f32 v85, v85
    v_cvt_pk_bf16_f32 v73, v82, v83
    s_waitcnt lgkmcnt(8)
    v_mfma_f32_32x32x16_bf16 v[48:63], a[56:59], v[44:47], v[48:63]
    ds_read_b64_tr_b16 a[48:49], v236 offset:12288
    ds_read_b64_tr_b16 a[50:51], v236 offset:13312
    v_exp_f32 v86, v86
    v_exp_f32 v87, v87
    v_cvt_pk_bf16_f32 v74, v84, v85
    v_mfma_f32_32x32x16_bf16 v[192:207], a[60:63], v[68:71], v[192:207]
    ds_read_b64_tr_b16 a[52:53], v237 offset:12288
    ds_read_b64_tr_b16 a[54:55], v237 offset:13312
    v_exp_f32 v88, v88
    s_waitcnt vmcnt(10)
    s_barrier
    s_add_u32 m0, s35, 122752
    s_waitcnt lgkmcnt(8)
    v_mfma_f32_32x32x16_bf16 v[48:63], a[64:67], v[64:67], v[48:63]
    ds_read_b64_tr_b16 a[56:57], v236 offset:36864
    ds_read_b64_tr_b16 a[58:59], v236 offset:37888
    buffer_load_dwordx4 v248, s[20:23], s10 offen offset:128 lds
    v_exp_f32 v89, v89
    v_cvt_pk_bf16_f32 v75, v86, v87
    v_mfma_f32_32x32x16_bf16 v[208:223], a[68:71], v[68:71], v[208:223]
    ds_read_b64_tr_b16 a[60:61], v237 offset:36864
    ds_read_b64_tr_b16 a[62:63], v237 offset:37888
    v_exp_f32 v90, v90
    v_exp_f32 v91, v91
    s_add_u32 m0, s35, 121728
    s_waitcnt lgkmcnt(8)
    v_mfma_f32_32x32x16_bf16 v[16:31], a[40:43], v[68:71], v[16:31]
    ds_read_b64_tr_b16 a[64:65], v236 offset:14336
    ds_read_b64_tr_b16 a[66:67], v236 offset:15360
    buffer_load_dwordx4 v248, s[20:23], s10 offen offset:2176 lds
    v_cvt_pk_bf16_f32 v76, v88, v89
    v_exp_f32 v92, v92
    v_mfma_f32_32x32x16_bf16 v[48:63], a[44:47], v[68:71], v[48:63]
    ds_read_b64_tr_b16 a[68:69], v237 offset:14336
    ds_read_b64_tr_b16 a[70:71], v237 offset:15360
    v_exp_f32 v93, v93
    v_cvt_pk_bf16_f32 v77, v90, v91
    s_add_u32 m0, s35, 130944
    s_waitcnt lgkmcnt(8)
    v_mfma_f32_32x32x16_bf16 v[192:207], a[48:51], v[72:75], v[192:207]
    ds_read_b64_tr_b16 a[40:41], v236 offset:38912
    ds_read_b64_tr_b16 a[42:43], v236 offset:39936
    buffer_load_dwordx4 v248, s[20:23], s11 offen offset:128 lds
    v_exp_f32 v94, v94
    v_exp_f32 v95, v95
    v_mfma_f32_32x32x16_bf16 v[208:223], a[52:55], v[72:75], v[208:223]
    ds_read_b64_tr_b16 a[44:45], v237 offset:38912
    ds_read_b64_tr_b16 a[46:47], v237 offset:39936
    v_cvt_pk_bf16_f32 v78, v92, v93
    v_cvt_pk_bf16_f32 v79, v94, v95
    s_add_u32 m0, s35, 129920
    s_waitcnt lgkmcnt(8)
    v_mfma_f32_32x32x16_bf16 v[16:31], a[56:59], v[72:75], v[16:31]
    ds_read_b128 a[48:51], v234 offset:16384
    buffer_load_dwordx4 v248, s[20:23], s11 offen offset:2176 lds
    v_exp_f32 v96, v96
    v_exp_f32 v97, v97
    v_mfma_f32_32x32x16_bf16 v[48:63], a[60:63], v[72:75], v[48:63]
    ds_read_b128 a[52:55], v232 offset:20480
    v_exp_f32 v98, v98
    v_exp_f32 v99, v99
    v_smfmac_f32_16x16x64_bf16 a[36:39], a[32:35], v[72:79], v249
    v_cvt_pk_bf16_f32 v96, v96, v97
    v_exp_f32 v100, v100
    s_waitcnt lgkmcnt(6)
    v_mfma_f32_32x32x16_bf16 v[192:207], a[64:67], v[76:79], v[192:207]
    ds_read_b128 a[56:59], v235 offset:16384
    v_exp_f32 v101, v101
    v_cvt_pk_bf16_f32 v97, v98, v99
    v_exp_f32 v102, v102
    v_mfma_f32_32x32x16_bf16 v[208:223], a[68:71], v[76:79], v[208:223]
    ds_read_b64_tr_b16 a[60:61], v236 offset:40960
    ds_read_b64_tr_b16 a[62:63], v236 offset:41984
    v_exp_f32 v103, v103
    v_cvt_pk_bf16_f32 v98, v100, v101
    s_waitcnt lgkmcnt(5)
    v_mfma_f32_32x32x16_bf16 v[16:31], a[40:43], v[76:79], v[16:31]
    ds_read_b64_tr_b16 a[64:65], v237 offset:40960
    ds_read_b64_tr_b16 a[66:67], v237 offset:41984
    v_exp_f32 v104, v104
    v_exp_f32 v105, v105
    v_mfma_f32_32x32x16_bf16 v[48:63], a[44:47], v[76:79], v[48:63]
    ds_read_b64_tr_b16 a[68:69], v236 offset:49152
    ds_read_b64_tr_b16 a[70:71], v236 offset:50176
    v_cvt_pk_bf16_f32 v99, v102, v103
    s_waitcnt vmcnt(8)
    s_barrier
    s_waitcnt lgkmcnt(7)
    v_mfma_f32_32x32x16_bf16 v[128:143], a[48:51], a[24:27], v[128:143]
    ds_read_b64_tr_b16 a[40:41], v237 offset:49152
    ds_read_b64_tr_b16 a[42:43], v237 offset:50176
    v_exp_f32 v106, v106
    v_exp_f32 v107, v107
    v_mfma_f32_32x32x16_bf16 v[144:159], a[52:55], a[16:19], v[144:159]
    ds_read_b64_tr_b16 a[44:45], v236 offset:43008
    ds_read_b64_tr_b16 a[46:47], v236 offset:44032
    v_cvt_pk_bf16_f32 v100, v104, v105
    v_exp_f32 v108, v108
    s_waitcnt lgkmcnt(8)
    v_mfma_f32_32x32x16_bf16 v[128:143], a[56:59], a[28:31], v[128:143]
    ds_read_b64_tr_b16 a[48:49], v237 offset:43008
    ds_read_b64_tr_b16 a[50:51], v237 offset:44032
    v_exp_f32 v109, v109
    v_cvt_pk_bf16_f32 v101, v106, v107
    v_mfma_f32_32x32x16_bf16 v[192:207], a[60:63], v[96:99], v[192:207]
    ds_read_b64_tr_b16 a[52:53], v236 offset:51200
    ds_read_b64_tr_b16 a[54:55], v236 offset:52224
    v_exp_f32 v110, v110
    v_exp_f32 v111, v111
    s_waitcnt lgkmcnt(8)
    v_mfma_f32_32x32x16_bf16 v[208:223], a[64:67], v[96:99], v[208:223]
    ds_read_b64_tr_b16 a[56:57], v237 offset:51200
    ds_read_b64_tr_b16 a[58:59], v237 offset:52224
    v_cvt_pk_bf16_f32 v102, v108, v109
    v_cvt_pk_bf16_f32 v103, v110, v111
    v_mfma_f32_32x32x16_bf16 v[16:31], a[68:71], v[96:99], v[16:31]
    ds_read_b128 a[60:63], v233 offset:20480
    v_exp_f32 v112, v112
    v_exp_f32 v113, v113
    s_waitcnt lgkmcnt(7)
    v_mfma_f32_32x32x16_bf16 v[48:63], a[40:43], v[96:99], v[48:63]
    ds_read_b128 a[64:67], v224 offset:57344
    v_exp_f32 v114, v114
    v_exp_f32 v115, v115
    v_smfmac_f32_16x16x64_bf16 a[36:39], a[32:35], v[96:103], v249
    v_cvt_pk_bf16_f32 v104, v112, v113
    v_exp_f32 v116, v116
    v_mfma_f32_32x32x16_bf16 v[192:207], a[44:47], v[100:103], v[192:207]
    ds_read_b128 a[68:71], v234 offset:20480
    v_exp_f32 v117, v117
    v_cvt_pk_bf16_f32 v105, v114, v115
    v_exp_f32 v118, v118
    s_waitcnt lgkmcnt(5)
    v_mfma_f32_32x32x16_bf16 v[208:223], a[48:51], v[100:103], v[208:223]
    ds_read_b64_tr_b16 a[40:41], v236 offset:45056
    ds_read_b64_tr_b16 a[42:43], v236 offset:46080
    v_exp_f32 v119, v119
    v_cvt_pk_bf16_f32 v106, v116, v117
    v_mfma_f32_32x32x16_bf16 v[16:31], a[52:55], v[100:103], v[16:31]
    ds_read_b64_tr_b16 a[44:45], v237 offset:45056
    ds_read_b64_tr_b16 a[46:47], v237 offset:46080
    v_exp_f32 v120, v120
    v_exp_f32 v121, v121
    s_waitcnt lgkmcnt(6)
    v_mfma_f32_32x32x16_bf16 v[48:63], a[56:59], v[100:103], v[48:63]
    ds_read_b64_tr_b16 a[48:49], v236 offset:53248
    ds_read_b64_tr_b16 a[50:51], v236 offset:54272
    v_cvt_pk_bf16_f32 v107, v118, v119
    v_exp_f32 v122, v122
    v_mfma_f32_32x32x16_bf16 v[144:159], a[60:63], a[20:23], v[144:159]
    ds_read_b64_tr_b16 a[52:53], v237 offset:53248
    ds_read_b64_tr_b16 a[54:55], v237 offset:54272
    v_exp_f32 v123, v123
    s_waitcnt vmcnt(6)
    s_barrier
    s_waitcnt lgkmcnt(8)
    v_mfma_f32_32x32x16_bf16 v[160:175], a[64:67], a[16:19], v[160:175]
    ds_read_b64_tr_b16 a[56:57], v236 offset:47104
    ds_read_b64_tr_b16 a[58:59], v236 offset:48128
    v_cvt_pk_bf16_f32 v108, v120, v121
    v_exp_f32 v124, v124
    v_mfma_f32_32x32x16_bf16 v[144:159], a[68:71], a[24:27], v[144:159]
    ds_read_b64_tr_b16 a[60:61], v237 offset:47104
    ds_read_b64_tr_b16 a[62:63], v237 offset:48128
    v_exp_f32 v125, v125
    v_cvt_pk_bf16_f32 v109, v122, v123
    s_waitcnt lgkmcnt(8)
    v_mfma_f32_32x32x16_bf16 v[192:207], a[40:43], v[104:107], v[192:207]
    ds_read_b64_tr_b16 a[64:65], v236 offset:55296
    ds_read_b64_tr_b16 a[66:67], v236 offset:56320
    v_exp_f32 v126, v126
    v_exp_f32 v127, v127
    v_mfma_f32_32x32x16_bf16 v[208:223], a[44:47], v[104:107], v[208:223]
    ds_read_b64_tr_b16 a[68:69], v237 offset:55296
    ds_read_b64_tr_b16 a[70:71], v237 offset:56320
    v_cvt_pk_bf16_f32 v110, v124, v125
    v_cvt_pk_bf16_f32 v111, v126, v127
    s_waitcnt lgkmcnt(8)
    v_mfma_f32_32x32x16_bf16 v[16:31], a[48:51], v[104:107], v[16:31]
    ds_read_b128 a[40:43], v235 offset:20480
    v_exp_f32 v128, v128
    v_exp_f32 v129, v129
    v_mfma_f32_32x32x16_bf16 v[48:63], a[52:55], v[104:107], v[48:63]
    ds_read_b128 a[44:47], v225 offset:57344
    v_exp_f32 v130, v130
    v_exp_f32 v131, v131
    v_smfmac_f32_16x16x64_bf16 a[36:39], a[32:35], v[104:111], v249
    v_cvt_pk_bf16_f32 v128, v128, v129
    v_exp_f32 v132, v132
    s_waitcnt lgkmcnt(6)
    v_mfma_f32_32x32x16_bf16 v[192:207], a[56:59], v[108:111], v[192:207]
    ds_read_b128 a[48:51], v224 offset:61440
    v_exp_f32 v133, v133
    v_cvt_pk_bf16_f32 v129, v130, v131
    v_exp_f32 v134, v134
    v_mfma_f32_32x32x16_bf16 v[208:223], a[60:63], v[108:111], v[208:223]
    ds_read_b64_tr_b16 a[52:53], v236 offset:16384
    ds_read_b64_tr_b16 a[54:55], v236 offset:17408
    v_exp_f32 v135, v135
    v_cvt_pk_bf16_f32 v130, v132, v133
    s_waitcnt lgkmcnt(5)
    v_mfma_f32_32x32x16_bf16 v[16:31], a[64:67], v[108:111], v[16:31]
    ds_read_b64_tr_b16 a[56:57], v237 offset:16384
    ds_read_b64_tr_b16 a[58:59], v237 offset:17408
    v_exp_f32 v136, v136
    v_exp_f32 v137, v137
    v_mfma_f32_32x32x16_bf16 v[48:63], a[68:71], v[108:111], v[48:63]
    ds_read_b64_tr_b16 a[60:61], v236 offset:24576
    ds_read_b64_tr_b16 a[62:63], v236 offset:25600
    v_cvt_pk_bf16_f32 v131, v134, v135
    v_exp_f32 v138, v138
    s_waitcnt lgkmcnt(7)
    v_mfma_f32_32x32x16_bf16 v[144:159], a[40:43], a[28:31], v[144:159]
    ds_read_b64_tr_b16 a[64:65], v237 offset:24576
    ds_read_b64_tr_b16 a[66:67], v237 offset:25600
    v_exp_f32 v139, v139
    v_cvt_pk_bf16_f32 v132, v136, v137
    v_mfma_f32_32x32x16_bf16 v[160:175], a[44:47], a[20:23], v[160:175]
    ds_read_b64_tr_b16 a[68:69], v236 offset:18432
    ds_read_b64_tr_b16 a[70:71], v236 offset:19456
    v_exp_f32 v140, v140
    s_waitcnt vmcnt(4)
    s_barrier
    s_waitcnt lgkmcnt(8)
    v_mfma_f32_32x32x16_bf16 v[176:191], a[48:51], a[16:19], v[176:191]
    ds_read_b64_tr_b16 a[40:41], v237 offset:18432
    ds_read_b64_tr_b16 a[42:43], v237 offset:19456
    v_exp_f32 v141, v141
    v_cvt_pk_bf16_f32 v133, v138, v139
    v_mfma_f32_32x32x16_bf16 v[192:207], a[52:55], v[128:131], v[192:207]
    ds_read_b64_tr_b16 a[44:45], v236 offset:26624
    ds_read_b64_tr_b16 a[46:47], v236 offset:27648
    v_exp_f32 v142, v142
    v_exp_f32 v143, v143
    s_waitcnt lgkmcnt(8)
    v_mfma_f32_32x32x16_bf16 v[208:223], a[56:59], v[128:131], v[208:223]
    ds_read_b64_tr_b16 a[48:49], v237 offset:26624
    ds_read_b64_tr_b16 a[50:51], v237 offset:27648
    v_cvt_pk_bf16_f32 v134, v140, v141
    v_cvt_pk_bf16_f32 v135, v142, v143
    v_mfma_f32_32x32x16_bf16 v[16:31], a[60:63], v[128:131], v[16:31]
    ds_read_b128 a[52:55], v226 offset:57344
    v_exp_f32 v144, v144
    v_exp_f32 v145, v145
    s_waitcnt lgkmcnt(7)
    v_mfma_f32_32x32x16_bf16 v[48:63], a[64:67], v[128:131], v[48:63]
    ds_read_b128 a[56:59], v225 offset:61440
    v_exp_f32 v146, v146
    v_exp_f32 v147, v147
    v_smfmac_f32_16x16x64_bf16 a[36:39], a[32:35], v[128:135], v249
    v_cvt_pk_bf16_f32 v136, v144, v145
    v_exp_f32 v148, v148
    v_mfma_f32_32x32x16_bf16 v[192:207], a[68:71], v[132:135], v[192:207]
    ds_read_b128 a[60:63], v227 offset:57344
    v_exp_f32 v149, v149
    v_cvt_pk_bf16_f32 v137, v146, v147
    v_exp_f32 v150, v150
    s_waitcnt lgkmcnt(5)
    v_mfma_f32_32x32x16_bf16 v[208:223], a[40:43], v[132:135], v[208:223]
    ds_read_b64_tr_b16 a[64:65], v236 offset:20480
    ds_read_b64_tr_b16 a[66:67], v236 offset:21504
    v_exp_f32 v151, v151
    v_cvt_pk_bf16_f32 v138, v148, v149
    v_mfma_f32_32x32x16_bf16 v[16:31], a[44:47], v[132:135], v[16:31]
    ds_read_b64_tr_b16 a[68:69], v237 offset:20480
    ds_read_b64_tr_b16 a[70:71], v237 offset:21504
    v_exp_f32 v152, v152
    v_exp_f32 v153, v153
    s_waitcnt lgkmcnt(6)
    v_mfma_f32_32x32x16_bf16 v[48:63], a[48:51], v[132:135], v[48:63]
    ds_read_b64_tr_b16 a[40:41], v236 offset:28672
    ds_read_b64_tr_b16 a[42:43], v236 offset:29696
    v_cvt_pk_bf16_f32 v139, v150, v151
    v_exp_f32 v154, v154
    v_mfma_f32_32x32x16_bf16 v[160:175], a[52:55], a[24:27], v[160:175]
    ds_read_b64_tr_b16 a[44:45], v237 offset:28672
    ds_read_b64_tr_b16 a[46:47], v237 offset:29696
    v_exp_f32 v155, v155
    v_cvt_pk_bf16_f32 v140, v152, v153
    s_waitcnt lgkmcnt(8)
    v_mfma_f32_32x32x16_bf16 v[176:191], a[56:59], a[20:23], v[176:191]
    ds_read_b64_tr_b16 a[48:49], v236 offset:22528
    ds_read_b64_tr_b16 a[50:51], v236 offset:23552
    v_exp_f32 v156, v156
    v_exp_f32 v157, v157
    v_mfma_f32_32x32x16_bf16 v[160:175], a[60:63], a[28:31], v[160:175]
    ds_read_b64_tr_b16 a[52:53], v237 offset:22528
    ds_read_b64_tr_b16 a[54:55], v237 offset:23552
    v_cvt_pk_bf16_f32 v141, v154, v155
    s_waitcnt vmcnt(0)
    s_barrier
    s_waitcnt lgkmcnt(8)
    v_mfma_f32_32x32x16_bf16 v[192:207], a[64:67], v[136:139], v[192:207]
    ds_read_b64_tr_b16 a[56:57], v236 offset:30720
    ds_read_b64_tr_b16 a[58:59], v236 offset:31744
    v_exp_f32 v158, v158
    v_exp_f32 v159, v159
    v_mfma_f32_32x32x16_bf16 v[208:223], a[68:71], v[136:139], v[208:223]
    ds_read_b64_tr_b16 a[60:61], v237 offset:30720
    ds_read_b64_tr_b16 a[62:63], v237 offset:31744
    v_cvt_pk_bf16_f32 v142, v156, v157
    v_cvt_pk_bf16_f32 v143, v158, v159
    s_waitcnt lgkmcnt(8)
    v_mfma_f32_32x32x16_bf16 v[16:31], a[40:43], v[136:139], v[16:31]
    ds_read_b128 a[64:67], v226 offset:61440
    v_exp_f32 v160, v160
    v_exp_f32 v161, v161
    v_mfma_f32_32x32x16_bf16 v[48:63], a[44:47], v[136:139], v[48:63]
    ds_read_b128 a[68:71], v224 offset:0
    v_exp_f32 v162, v162
    v_exp_f32 v163, v163
    v_smfmac_f32_16x16x64_bf16 a[36:39], a[32:35], v[136:143], v249
    v_cvt_pk_bf16_f32 v160, v160, v161
    s_waitcnt lgkmcnt(6)
    v_mfma_f32_32x32x16_bf16 v[192:207], a[48:51], v[140:143], v[192:207]
    ds_read_b128 a[40:43], v227 offset:61440
    v_exp_f32 v164, v164
    v_exp_f32 v165, v165
    v_mfma_f32_32x32x16_bf16 v[208:223], a[52:55], v[140:143], v[208:223]
    ds_read_b128 a[44:47], v225 offset:0
    v_cvt_pk_bf16_f32 v161, v162, v163
    v_exp_f32 v166, v166
    s_waitcnt lgkmcnt(4)
    v_mfma_f32_32x32x16_bf16 v[16:31], a[56:59], v[140:143], v[16:31]
    ds_read_b128 a[48:51], v224 offset:4096
    v_exp_f32 v167, v167
    v_cvt_pk_bf16_f32 v162, v164, v165
    v_mfma_f32_32x32x16_bf16 v[48:63], a[60:63], v[140:143], v[48:63]
    ds_read_b128 a[52:55], v226 offset:0
    v_exp_f32 v168, v168
    v_exp_f32 v169, v169
    s_waitcnt lgkmcnt(4)
    v_mfma_f32_32x32x16_bf16 v[176:191], a[64:67], a[24:27], v[176:191]
    ds_read_b128 a[56:59], v225 offset:4096
    v_cvt_pk_bf16_f32 v163, v166, v167
    v_exp_f32 v170, v170
    v_mov_b32 v80, v250
    v_mov_b32 v81, v250
    v_mov_b32 v82, v250
    v_mov_b32 v83, v250
    v_mov_b32 v84, v250
    v_mov_b32 v85, v250
    v_mov_b32 v86, v250
    v_mov_b32 v87, v250
    v_mov_b32 v88, v250
    v_mov_b32 v89, v250
    v_mov_b32 v90, v250
    v_mov_b32 v91, v250
    v_mov_b32 v92, v250
    v_mov_b32 v93, v250
    v_mov_b32 v94, v250
    v_mov_b32 v95, v250
    s_nop 1
    v_mfma_f32_32x32x16_bf16 v[80:95], a[68:71], a[0:3], v[80:95]
    ds_read_b128 a[60:63], v227 offset:0
    v_exp_f32 v171, v171
    v_cvt_pk_bf16_f32 v164, v168, v169
    s_waitcnt lgkmcnt(4)
    v_mfma_f32_32x32x16_bf16 v[176:191], a[40:43], a[28:31], v[176:191]
    ds_read_b128 a[64:67], v226 offset:4096
    v_exp_f32 v172, v172
    v_exp_f32 v173, v173
    v_mfma_f32_32x32x16_bf16 v[80:95], a[44:47], a[4:7], v[80:95]
    ds_read_b128 a[68:71], v228 offset:0
    v_cvt_pk_bf16_f32 v165, v170, v171
    v_exp_f32 v174, v174
    s_waitcnt lgkmcnt(4)
    v_mov_b32 v112, v250
    v_mov_b32 v113, v250
    v_mov_b32 v114, v250
    v_mov_b32 v115, v250
    v_mov_b32 v116, v250
    v_mov_b32 v117, v250
    v_mov_b32 v118, v250
    v_mov_b32 v119, v250
    v_mov_b32 v120, v250
    v_mov_b32 v121, v250
    v_mov_b32 v122, v250
    v_mov_b32 v123, v250
    v_mov_b32 v124, v250
    v_mov_b32 v125, v250
    v_mov_b32 v126, v250
    v_mov_b32 v127, v250
    s_nop 1
    v_mfma_f32_32x32x16_bf16 v[112:127], a[48:51], a[0:3], v[112:127]
    ds_read_b128 a[40:43], v227 offset:4096
    v_exp_f32 v175, v175
    v_cvt_pk_bf16_f32 v166, v172, v173
    v_cvt_pk_bf16_f32 v167, v174, v175
    v_mfma_f32_32x32x16_bf16 v[80:95], a[52:55], a[8:11], v[80:95]
    ds_read_b128 a[44:47], v229 offset:0
    v_exp_f32 v176, v176
    v_exp_f32 v177, v177
    s_waitcnt lgkmcnt(4)
    v_mfma_f32_32x32x16_bf16 v[112:127], a[56:59], a[4:7], v[112:127]
    ds_read_b128 a[48:51], v228 offset:4096
    v_exp_f32 v178, v178
    v_exp_f32 v179, v179
    v_smfmac_f32_16x16x64_bf16 a[36:39], a[32:35], v[160:167], v249
    v_cvt_pk_bf16_f32 v168, v176, v177
    v_exp_f32 v180, v180
    v_mfma_f32_32x32x16_bf16 v[80:95], a[60:63], a[12:15], v[80:95]
    ds_read_b128 a[52:55], v230 offset:0
    v_exp_f32 v181, v181
    v_cvt_pk_bf16_f32 v169, v178, v179
    s_waitcnt lgkmcnt(4)
    v_mfma_f32_32x32x16_bf16 v[112:127], a[64:67], a[8:11], v[112:127]
    ds_read_b128 a[56:59], v229 offset:4096
    v_exp_f32 v182, v182
    v_exp_f32 v183, v183
    v_cvt_pk_bf16_f32 v170, v180, v181
    v_mfma_f32_32x32x16_bf16 v[80:95], a[68:71], a[16:19], v[80:95]
    ds_read_b128 a[60:63], v231 offset:0
    v_exp_f32 v184, v184
    v_exp_f32 v185, v185
    s_waitcnt lgkmcnt(4)
    v_mfma_f32_32x32x16_bf16 v[112:127], a[40:43], a[12:15], v[112:127]
    ds_read_b64_tr_b16 a[64:65], v238 offset:8192
    ds_read_b64_tr_b16 a[66:67], v238 offset:9216
    v_cvt_pk_bf16_f32 v171, v182, v183
    v_exp_f32 v186, v186
    v_mfma_f32_32x32x16_bf16 v[80:95], a[44:47], a[20:23], v[80:95]
    ds_read_b64_tr_b16 a[68:69], v239 offset:8192
    ds_read_b64_tr_b16 a[70:71], v239 offset:9216
    v_exp_f32 v187, v187
    v_cvt_pk_bf16_f32 v172, v184, v185
    s_waitcnt lgkmcnt(6)
    v_mfma_f32_32x32x16_bf16 v[112:127], a[48:51], a[16:19], v[112:127]
    ds_read_b64_tr_b16 a[40:41], v238 offset:16384
    ds_read_b64_tr_b16 a[42:43], v238 offset:17408
    v_exp_f32 v188, v188
    v_exp_f32 v189, v189
    v_mfma_f32_32x32x16_bf16 v[80:95], a[52:55], a[24:27], v[80:95]
    ds_read_b64_tr_b16 a[44:45], v239 offset:16384
    ds_read_b64_tr_b16 a[46:47], v239 offset:17408
    v_cvt_pk_bf16_f32 v173, v186, v187
    v_exp_f32 v190, v190
    s_waitcnt lgkmcnt(8)
    v_mfma_f32_32x32x16_bf16 v[112:127], a[56:59], a[20:23], v[112:127]
    ds_read_b64_tr_b16 a[48:49], v238 offset:10240
    ds_read_b64_tr_b16 a[50:51], v238 offset:11264
    v_exp_f32 v191, v191
    v_cvt_pk_bf16_f32 v174, v188, v189
    v_cvt_pk_bf16_f32 v175, v190, v191
    v_mfma_f32_32x32x16_bf16 v[80:95], a[60:63], a[28:31], v[80:95]
    ds_read_b64_tr_b16 a[52:53], v239 offset:10240
    ds_read_b64_tr_b16 a[54:55], v239 offset:11264
    s_waitcnt lgkmcnt(8)
    v_mfma_f32_32x32x16_bf16 v[192:207], a[64:67], v[160:163], v[192:207]
    ds_read_b128 a[56:59], v230 offset:4096
    s_nop 6
    v_exp_f32 v80, v80
    v_exp_f32 v81, v81
    v_mfma_f32_32x32x16_bf16 v[208:223], a[68:71], v[160:163], v[208:223]
    ds_read_b128 a[60:63], v228 offset:24576
    v_exp_f32 v82, v82
    v_exp_f32 v83, v83
    v_smfmac_f32_16x16x64_bf16 a[36:39], a[32:35], v[168:175], v249
    v_cvt_pk_bf16_f32 v80, v80, v81
    s_waitcnt lgkmcnt(6)
    v_mfma_f32_32x32x16_bf16 v[16:31], a[40:43], v[160:163], v[16:31]
    ds_read_b128 a[64:67], v231 offset:4096
    v_exp_f32 v84, v84
    v_exp_f32 v85, v85
    v_mfma_f32_32x32x16_bf16 v[48:63], a[44:47], v[160:163], v[48:63]
    ds_read_b128 a[68:71], v229 offset:24576
    v_cvt_pk_bf16_f32 v81, v82, v83
    v_exp_f32 v86, v86
    s_waitcnt lgkmcnt(4)
    v_mfma_f32_32x32x16_bf16 v[192:207], a[48:51], v[164:167], v[192:207]
    ds_read_b128 a[40:43], v228 offset:28672
    v_exp_f32 v87, v87
    v_cvt_pk_bf16_f32 v82, v84, v85
    v_mfma_f32_32x32x16_bf16 v[208:223], a[52:55], v[164:167], v[208:223]
    ds_read_b128 a[44:47], v230 offset:24576
    v_exp_f32 v88, v88
    v_exp_f32 v89, v89
    s_waitcnt lgkmcnt(4)
    v_mfma_f32_32x32x16_bf16 v[112:127], a[56:59], a[24:27], v[112:127]
    ds_read_b128 a[48:51], v229 offset:28672
    v_cvt_pk_bf16_f32 v83, v86, v87
    v_exp_f32 v90, v90
    v_mov_b32 v144, v250
    v_mov_b32 v145, v250
    v_mov_b32 v146, v250
    v_mov_b32 v147, v250
    v_mov_b32 v148, v250
    v_mov_b32 v149, v250
    v_mov_b32 v150, v250
    v_mov_b32 v151, v250
    v_mov_b32 v152, v250
    v_mov_b32 v153, v250
    v_mov_b32 v154, v250
    v_mov_b32 v155, v250
    v_mov_b32 v156, v250
    v_mov_b32 v157, v250
    v_mov_b32 v158, v250
    v_mov_b32 v159, v250
    s_nop 1
    v_mfma_f32_32x32x16_bf16 v[144:159], a[60:63], a[0:3], v[144:159]
    ds_read_b128 a[52:55], v231 offset:24576
    v_exp_f32 v91, v91
    v_cvt_pk_bf16_f32 v84, v88, v89
    s_waitcnt lgkmcnt(4)
    v_mfma_f32_32x32x16_bf16 v[112:127], a[64:67], a[28:31], v[112:127]
    ds_read_b128 a[56:59], v230 offset:28672
    v_exp_f32 v92, v92
    v_exp_f32 v93, v93
    v_mfma_f32_32x32x16_bf16 v[144:159], a[68:71], a[4:7], v[144:159]
    ds_read_b128 a[60:63], v228 offset:32768
    v_cvt_pk_bf16_f32 v85, v90, v91
    v_exp_f32 v94, v94
    s_waitcnt lgkmcnt(4)
    v_mov_b32 v176, v250
    v_mov_b32 v177, v250
    v_mov_b32 v178, v250
    v_mov_b32 v179, v250
    v_mov_b32 v180, v250
    v_mov_b32 v181, v250
    v_mov_b32 v182, v250
    v_mov_b32 v183, v250
    v_mov_b32 v184, v250
    v_mov_b32 v185, v250
    v_mov_b32 v186, v250
    v_mov_b32 v187, v250
    v_mov_b32 v188, v250
    v_mov_b32 v189, v250
    v_mov_b32 v190, v250
    v_mov_b32 v191, v250
    s_nop 1
    v_mfma_f32_32x32x16_bf16 v[176:191], a[40:43], a[0:3], v[176:191]
    ds_read_b128 a[64:67], v231 offset:28672
    v_exp_f32 v95, v95
    v_cvt_pk_bf16_f32 v86, v92, v93
    v_cvt_pk_bf16_f32 v87, v94, v95
    v_mfma_f32_32x32x16_bf16 v[144:159], a[44:47], a[8:11], v[144:159]
    ds_read_b128 a[68:71], v229 offset:32768
    v_exp_f32 v112, v112
    v_exp_f32 v113, v113
    s_waitcnt lgkmcnt(4)
    v_mfma_f32_32x32x16_bf16 v[176:191], a[48:51], a[4:7], v[176:191]
    ds_read_b128 a[40:43], v228 offset:36864
    v_exp_f32 v114, v114
    v_exp_f32 v115, v115
    v_smfmac_f32_16x16x64_bf16 a[36:39], a[32:35], v[80:87], v249
    v_cvt_pk_bf16_f32 v88, v112, v113
    v_exp_f32 v116, v116
    v_mfma_f32_32x32x16_bf16 v[144:159], a[52:55], a[12:15], v[144:159]
    ds_read_b128 a[44:47], v230 offset:32768
    v_exp_f32 v117, v117
    v_cvt_pk_bf16_f32 v89, v114, v115
    s_waitcnt lgkmcnt(4)
    v_mfma_f32_32x32x16_bf16 v[176:191], a[56:59], a[8:11], v[176:191]
    ds_read_b128 a[48:51], v229 offset:36864
    v_exp_f32 v118, v118
    v_exp_f32 v119, v119
    v_cvt_pk_bf16_f32 v90, v116, v117
    v_mfma_f32_32x32x16_bf16 v[144:159], a[60:63], a[16:19], v[144:159]
    ds_read_b128 a[52:55], v231 offset:32768
    v_exp_f32 v120, v120
    v_exp_f32 v121, v121
    s_waitcnt lgkmcnt(4)
    v_mfma_f32_32x32x16_bf16 v[176:191], a[64:67], a[12:15], v[176:191]
    ds_read_b64_tr_b16 a[56:57], v238 offset:18432
    ds_read_b64_tr_b16 a[58:59], v238 offset:19456
    v_cvt_pk_bf16_f32 v91, v118, v119
    v_exp_f32 v122, v122
    v_mfma_f32_32x32x16_bf16 v[144:159], a[68:71], a[20:23], v[144:159]
    ds_read_b64_tr_b16 a[60:61], v239 offset:18432
    ds_read_b64_tr_b16 a[62:63], v239 offset:19456
    v_exp_f32 v123, v123
    v_cvt_pk_bf16_f32 v92, v120, v121
    s_waitcnt lgkmcnt(6)
    v_mfma_f32_32x32x16_bf16 v[176:191], a[40:43], a[16:19], v[176:191]
    ds_read_b64_tr_b16 a[64:65], v238 offset:12288
    ds_read_b64_tr_b16 a[66:67], v238 offset:13312
    v_exp_f32 v124, v124
    v_exp_f32 v125, v125
    v_mfma_f32_32x32x16_bf16 v[144:159], a[44:47], a[24:27], v[144:159]
    ds_read_b64_tr_b16 a[68:69], v239 offset:12288
    ds_read_b64_tr_b16 a[70:71], v239 offset:13312
    v_cvt_pk_bf16_f32 v93, v122, v123
    v_exp_f32 v126, v126
    s_waitcnt lgkmcnt(8)
    v_mfma_f32_32x32x16_bf16 v[176:191], a[48:51], a[20:23], v[176:191]
    ds_read_b64_tr_b16 a[40:41], v238 offset:14336
    ds_read_b64_tr_b16 a[42:43], v238 offset:15360
    v_exp_f32 v127, v127
    v_cvt_pk_bf16_f32 v94, v124, v125
    v_cvt_pk_bf16_f32 v95, v126, v127
    v_mfma_f32_32x32x16_bf16 v[144:159], a[52:55], a[28:31], v[144:159]
    ds_read_b64_tr_b16 a[44:45], v239 offset:14336
    ds_read_b64_tr_b16 a[46:47], v239 offset:15360
    s_waitcnt lgkmcnt(8)
    v_mfma_f32_32x32x16_bf16 v[16:31], a[56:59], v[164:167], v[16:31]
    ds_read_b64_tr_b16 a[48:49], v238 offset:40960
    ds_read_b64_tr_b16 a[50:51], v238 offset:41984
    s_nop 5
    v_exp_f32 v144, v144
    v_exp_f32 v145, v145
    v_mfma_f32_32x32x16_bf16 v[48:63], a[60:63], v[164:167], v[48:63]
    ds_read_b128 a[52:55], v230 offset:36864
    v_exp_f32 v146, v146
    v_exp_f32 v147, v147
    v_smfmac_f32_16x16x64_bf16 a[36:39], a[32:35], v[88:95], v249
    v_cvt_pk_bf16_f32 v144, v144, v145
    v_exp_f32 v148, v148
    s_waitcnt lgkmcnt(7)
    v_mfma_f32_32x32x16_bf16 v[192:207], a[64:67], v[168:171], v[192:207]
    ds_read_b64_tr_b16 a[56:57], v239 offset:40960
    ds_read_b64_tr_b16 a[58:59], v239 offset:41984
    v_exp_f32 v149, v149
    v_cvt_pk_bf16_f32 v145, v146, v147
    v_mfma_f32_32x32x16_bf16 v[208:223], a[68:71], v[168:171], v[208:223]
    ds_read_b128 a[60:63], v231 offset:36864
    v_exp_f32 v150, v150
    v_exp_f32 v151, v151
    s_waitcnt lgkmcnt(6)
    v_mfma_f32_32x32x16_bf16 v[192:207], a[40:43], v[172:175], v[192:207]
    ds_read_b64_tr_b16 a[64:65], v238 offset:43008
    ds_read_b64_tr_b16 a[66:67], v238 offset:44032
    v_cvt_pk_bf16_f32 v146, v148, v149
    v_exp_f32 v152, v152
    v_mfma_f32_32x32x16_bf16 v[208:223], a[44:47], v[172:175], v[208:223]
    ds_read_b64_tr_b16 a[68:69], v239 offset:43008
    ds_read_b64_tr_b16 a[70:71], v239 offset:44032
    v_exp_f32 v153, v153
    v_cvt_pk_bf16_f32 v147, v150, v151
    s_waitcnt lgkmcnt(7)
    v_mfma_f32_32x32x16_bf16 v[192:207], a[48:51], v[80:83], v[192:207]
    ds_read_b64_tr_b16 a[40:41], v238 offset:45056
    ds_read_b64_tr_b16 a[42:43], v238 offset:46080
    v_exp_f32 v154, v154
    v_exp_f32 v155, v155
    v_mfma_f32_32x32x16_bf16 v[176:191], a[52:55], a[24:27], v[176:191]
    ds_read_b64_tr_b16 a[44:45], v239 offset:45056
    ds_read_b64_tr_b16 a[46:47], v239 offset:46080
    v_cvt_pk_bf16_f32 v148, v152, v153
    v_exp_f32 v156, v156
    s_waitcnt lgkmcnt(8)
    v_mfma_f32_32x32x16_bf16 v[208:223], a[56:59], v[80:83], v[208:223]
    ds_read_b64_tr_b16 a[48:49], v238 offset:47104
    ds_read_b64_tr_b16 a[50:51], v238 offset:48128
    v_exp_f32 v157, v157
    v_cvt_pk_bf16_f32 v149, v154, v155
    v_mfma_f32_32x32x16_bf16 v[176:191], a[60:63], a[28:31], v[176:191]
    ds_read_b64_tr_b16 a[52:53], v239 offset:47104
    ds_read_b64_tr_b16 a[54:55], v239 offset:48128
    v_exp_f32 v158, v158
    v_exp_f32 v159, v159
    s_waitcnt lgkmcnt(8)
    v_mfma_f32_32x32x16_bf16 v[192:207], a[64:67], v[84:87], v[192:207]
    ds_read_b64_tr_b16 a[56:57], v238 offset:49152
    ds_read_b64_tr_b16 a[58:59], v238 offset:50176
    v_cvt_pk_bf16_f32 v150, v156, v157
    v_cvt_pk_bf16_f32 v151, v158, v159
    v_mfma_f32_32x32x16_bf16 v[208:223], a[68:71], v[84:87], v[208:223]
    ds_read_b64_tr_b16 a[60:61], v239 offset:49152
    ds_read_b64_tr_b16 a[62:63], v239 offset:50176
    v_exp_f32 v176, v176
    v_exp_f32 v177, v177
    s_waitcnt lgkmcnt(8)
    v_mfma_f32_32x32x16_bf16 v[192:207], a[40:43], v[88:91], v[192:207]
    ds_read_b64_tr_b16 a[64:65], v238 offset:51200
    ds_read_b64_tr_b16 a[66:67], v238 offset:52224
    v_exp_f32 v178, v178
    v_exp_f32 v179, v179
    v_smfmac_f32_16x16x64_bf16 a[36:39], a[32:35], v[144:151], v249
    v_cvt_pk_bf16_f32 v152, v176, v177
    v_exp_f32 v180, v180
    v_mfma_f32_32x32x16_bf16 v[208:223], a[44:47], v[88:91], v[208:223]
    ds_read_b64_tr_b16 a[68:69], v239 offset:51200
    ds_read_b64_tr_b16 a[70:71], v239 offset:52224
    v_exp_f32 v181, v181
    v_cvt_pk_bf16_f32 v153, v178, v179
    s_waitcnt lgkmcnt(8)
    v_mfma_f32_32x32x16_bf16 v[192:207], a[48:51], v[92:95], v[192:207]
    ds_read_b64_tr_b16 a[40:41], v238 offset:53248
    ds_read_b64_tr_b16 a[42:43], v238 offset:54272
    v_exp_f32 v182, v182
    v_exp_f32 v183, v183
    v_mfma_f32_32x32x16_bf16 v[208:223], a[52:55], v[92:95], v[208:223]
    ds_read_b64_tr_b16 a[44:45], v239 offset:53248
    ds_read_b64_tr_b16 a[46:47], v239 offset:54272
    v_cvt_pk_bf16_f32 v154, v180, v181
    v_exp_f32 v184, v184
    s_waitcnt lgkmcnt(8)
    v_mfma_f32_32x32x16_bf16 v[192:207], a[56:59], v[144:147], v[192:207]
    ds_read_b64_tr_b16 a[48:49], v238 offset:55296
    ds_read_b64_tr_b16 a[50:51], v238 offset:56320
    v_exp_f32 v185, v185
    v_cvt_pk_bf16_f32 v155, v182, v183
    v_exp_f32 v186, v186
    v_mfma_f32_32x32x16_bf16 v[208:223], a[60:63], v[144:147], v[208:223]
    ds_read_b64_tr_b16 a[52:53], v239 offset:55296
    ds_read_b64_tr_b16 a[54:55], v239 offset:56320
    v_exp_f32 v187, v187
    v_cvt_pk_bf16_f32 v156, v184, v185
    s_waitcnt lgkmcnt(8)
    v_mfma_f32_32x32x16_bf16 v[192:207], a[64:67], v[148:151], v[192:207]
    ds_read_b64_tr_b16 a[56:57], v238 offset:20480
    ds_read_b64_tr_b16 a[58:59], v238 offset:21504
    v_exp_f32 v188, v188
    v_exp_f32 v189, v189
    v_mfma_f32_32x32x16_bf16 v[208:223], a[68:71], v[148:151], v[208:223]
    ds_read_b64_tr_b16 a[60:61], v239 offset:20480
    ds_read_b64_tr_b16 a[62:63], v239 offset:21504
    v_cvt_pk_bf16_f32 v157, v186, v187
    v_exp_f32 v190, v190
    s_waitcnt lgkmcnt(8)
    v_mfma_f32_32x32x16_bf16 v[192:207], a[40:43], v[152:155], v[192:207]
    ds_read_b64_tr_b16 a[64:65], v238 offset:22528
    ds_read_b64_tr_b16 a[66:67], v238 offset:23552
    v_exp_f32 v191, v191
    v_cvt_pk_bf16_f32 v158, v188, v189
    v_cvt_pk_bf16_f32 v159, v190, v191
    v_mfma_f32_32x32x16_bf16 v[208:223], a[44:47], v[152:155], v[208:223]
    ds_read_b64_tr_b16 a[68:69], v239 offset:22528
    ds_read_b64_tr_b16 a[70:71], v239 offset:23552
    s_waitcnt lgkmcnt(8)
    v_mfma_f32_32x32x16_bf16 v[192:207], a[48:51], v[156:159], v[192:207]
    ds_read_b64_tr_b16 a[40:41], v238 offset:57344
    ds_read_b64_tr_b16 a[42:43], v238 offset:58368
    v_smfmac_f32_16x16x64_bf16 a[36:39], a[32:35], v[152:159], v249
    v_mfma_f32_32x32x16_bf16 v[208:223], a[52:55], v[156:159], v[208:223]
    ds_read_b64_tr_b16 a[44:45], v239 offset:57344
    ds_read_b64_tr_b16 a[46:47], v239 offset:58368
    s_nop 7
    s_nop 0
    v_accvgpr_read_b32 v244, a36
    v_accvgpr_read_b32 v246, a37
    v_add_f32 v244, v244, v246
    v_rcp_f32 v252, v244
    s_waitcnt lgkmcnt(8)
    v_mfma_f32_32x32x16_bf16 v[16:31], a[56:59], v[168:171], v[16:31]
    ds_read_b64_tr_b16 a[48:49], v238 offset:59392
    ds_read_b64_tr_b16 a[50:51], v238 offset:60416
    v_mul_f32 v192, v252, v192
    v_mul_f32 v193, v252, v193
    v_mul_f32 v194, v252, v194
    v_mul_f32 v195, v252, v195
    v_mul_f32 v196, v252, v196
    v_mfma_f32_32x32x16_bf16 v[48:63], a[60:63], v[168:171], v[48:63]
    ds_read_b64_tr_b16 a[52:53], v239 offset:59392
    ds_read_b64_tr_b16 a[54:55], v239 offset:60416
    v_mul_f32 v197, v252, v197
    v_mul_f32 v198, v252, v198
    v_mul_f32 v199, v252, v199
    v_cvt_pk_bf16_f32 v176, v192, v193
    v_cvt_pk_bf16_f32 v177, v194, v195
    s_waitcnt lgkmcnt(8)
    v_mfma_f32_32x32x16_bf16 v[16:31], a[64:67], v[172:175], v[16:31]
    ds_read_b64_tr_b16 a[56:57], v238 offset:61440
    ds_read_b64_tr_b16 a[58:59], v238 offset:62464
    v_cvt_pk_bf16_f32 v178, v196, v197
    v_cvt_pk_bf16_f32 v179, v198, v199
    ds_write_b128 v254, v[176:179]
    v_mul_f32 v200, v252, v200
    v_mul_f32 v201, v252, v201
    v_mfma_f32_32x32x16_bf16 v[48:63], a[68:71], v[172:175], v[48:63]
    ds_read_b64_tr_b16 a[60:61], v239 offset:61440
    ds_read_b64_tr_b16 a[62:63], v239 offset:62464
    v_mul_f32 v202, v252, v202
    v_mul_f32 v203, v252, v203
    v_mul_f32 v204, v252, v204
    v_mul_f32 v205, v252, v205
    v_mul_f32 v206, v252, v206
    s_waitcnt lgkmcnt(9)
    v_mfma_f32_32x32x16_bf16 v[16:31], a[40:43], v[80:83], v[16:31]
    ds_read_b64_tr_b16 a[64:65], v238 offset:63488
    ds_read_b64_tr_b16 a[66:67], v238 offset:64512
    v_mul_f32 v207, v252, v207
    v_cvt_pk_bf16_f32 v180, v200, v201
    v_cvt_pk_bf16_f32 v181, v202, v203
    v_cvt_pk_bf16_f32 v182, v204, v205
    v_cvt_pk_bf16_f32 v183, v206, v207
    v_mfma_f32_32x32x16_bf16 v[48:63], a[44:47], v[80:83], v[48:63]
    ds_read_b64_tr_b16 a[68:69], v239 offset:63488
    ds_read_b64_tr_b16 a[70:71], v239 offset:64512
    v_xor_b32 v245, 16, v254
    ds_write_b128 v245, v[180:183]
    ds_read_b128 v[176:179], v255 offset:0
    ds_read_b128 v[180:183], v255 offset:1024
    s_waitcnt lgkmcnt(12)
    v_mfma_f32_32x32x16_bf16 v[16:31], a[48:51], v[84:87], v[16:31]
    ds_read_b64_tr_b16 a[40:41], v240 offset:0
    ds_read_b64_tr_b16 a[42:43], v240 offset:1024
    v_mul_f32 v208, v252, v208
    v_mul_f32 v209, v252, v209
    v_mul_f32 v210, v252, v210
    v_mul_f32 v211, v252, v211
    v_mul_f32 v212, v252, v212
    v_mfma_f32_32x32x16_bf16 v[48:63], a[52:55], v[84:87], v[48:63]
    ds_read_b64_tr_b16 a[44:45], v241 offset:0
    ds_read_b64_tr_b16 a[46:47], v241 offset:1024
    s_waitcnt lgkmcnt(5)
    buffer_store_dwordx4 v[176:179], v251, s[24:27], s32 offen offset:0 sc1
    v_mul_f32 v213, v252, v213
    v_mul_f32 v214, v252, v214
    v_mul_f32 v215, v252, v215
    v_cvt_pk_bf16_f32 v184, v208, v209
    v_cvt_pk_bf16_f32 v185, v210, v211
    v_mfma_f32_32x32x16_bf16 v[16:31], a[56:59], v[88:91], v[16:31]
    ds_read_b64_tr_b16 a[48:49], v240 offset:2048
    ds_read_b64_tr_b16 a[50:51], v240 offset:3072
    s_waitcnt lgkmcnt(6)
    buffer_store_dwordx4 v[180:183], v251, s[24:27], s42 offen offset:0 sc1
    v_cvt_pk_bf16_f32 v186, v212, v213
    v_cvt_pk_bf16_f32 v187, v214, v215
    ds_write_b128 v254, v[184:187]
    v_mul_f32 v216, v252, v216
    v_mul_f32 v217, v252, v217
    v_mfma_f32_32x32x16_bf16 v[48:63], a[60:63], v[88:91], v[48:63]
    ds_read_b64_tr_b16 a[52:53], v241 offset:2048
    ds_read_b64_tr_b16 a[54:55], v241 offset:3072
    v_mul_f32 v218, v252, v218
    v_mul_f32 v219, v252, v219
    v_mul_f32 v220, v252, v220
    v_mul_f32 v221, v252, v221
    v_mul_f32 v222, v252, v222
    v_mfma_f32_32x32x16_bf16 v[16:31], a[64:67], v[92:95], v[16:31]
    ds_read_b64_tr_b16 a[56:57], v240 offset:4096
    ds_read_b64_tr_b16 a[58:59], v240 offset:5120
    v_mul_f32 v223, v252, v223
    v_cvt_pk_bf16_f32 v188, v216, v217
    v_cvt_pk_bf16_f32 v189, v218, v219
    v_cvt_pk_bf16_f32 v190, v220, v221
    v_cvt_pk_bf16_f32 v191, v222, v223
    v_mfma_f32_32x32x16_bf16 v[48:63], a[68:71], v[92:95], v[48:63]
    ds_read_b64_tr_b16 a[60:61], v241 offset:4096
    ds_read_b64_tr_b16 a[62:63], v241 offset:5120
    v_xor_b32 v245, 16, v254
    ds_write_b128 v245, v[188:191]
    ds_read_b128 v[184:187], v255 offset:0
    ds_read_b128 v[188:191], v255 offset:1024
    s_waitcnt lgkmcnt(12)
    v_mfma_f32_32x32x16_bf16 v[16:31], a[40:43], v[144:147], v[16:31]
    ds_read_b64_tr_b16 a[64:65], v240 offset:6144
    ds_read_b64_tr_b16 a[66:67], v240 offset:7168
    v_mfma_f32_32x32x16_bf16 v[48:63], a[44:47], v[144:147], v[48:63]
    ds_read_b64_tr_b16 a[68:69], v241 offset:6144
    ds_read_b64_tr_b16 a[70:71], v241 offset:7168
    s_waitcnt lgkmcnt(5)
    buffer_store_dwordx4 v[184:187], v251, s[24:27], s32 offen offset:64 sc1
    v_mfma_f32_32x32x16_bf16 v[16:31], a[48:51], v[148:151], v[16:31]
    s_waitcnt lgkmcnt(4)
    buffer_store_dwordx4 v[188:191], v251, s[24:27], s42 offen offset:64 sc1
    v_mfma_f32_32x32x16_bf16 v[48:63], a[52:55], v[148:151], v[48:63]
    v_mfma_f32_32x32x16_bf16 v[16:31], a[56:59], v[152:155], v[16:31]
    v_mfma_f32_32x32x16_bf16 v[48:63], a[60:63], v[152:155], v[48:63]
    s_waitcnt lgkmcnt(0)
    v_mfma_f32_32x32x16_bf16 v[16:31], a[64:67], v[156:159], v[16:31]
    v_mfma_f32_32x32x16_bf16 v[48:63], a[68:71], v[156:159], v[48:63]
    s_nop 7
    s_nop 2
    v_mul_f32 v16, v252, v16
    v_mul_f32 v17, v252, v17
    v_mul_f32 v18, v252, v18
    v_mul_f32 v19, v252, v19
    v_mul_f32 v20, v252, v20
    v_mul_f32 v21, v252, v21
    v_mul_f32 v22, v252, v22
    v_mul_f32 v23, v252, v23
    v_cvt_pk_bf16_f32 v176, v16, v17
    v_cvt_pk_bf16_f32 v177, v18, v19
    v_cvt_pk_bf16_f32 v178, v20, v21
    v_cvt_pk_bf16_f32 v179, v22, v23
    ds_write_b128 v254, v[176:179]
    v_pk_mul_f32 v[24:25], v[24:25], v[252:253] op_sel_hi:[1,0]
    v_pk_mul_f32 v[26:27], v[26:27], v[252:253] op_sel_hi:[1,0]
    v_pk_mul_f32 v[28:29], v[28:29], v[252:253] op_sel_hi:[1,0]
    v_pk_mul_f32 v[30:31], v[30:31], v[252:253] op_sel_hi:[1,0]
    v_cvt_pk_bf16_f32 v180, v24, v25
    v_cvt_pk_bf16_f32 v181, v26, v27
    v_cvt_pk_bf16_f32 v182, v28, v29
    v_cvt_pk_bf16_f32 v183, v30, v31
    v_xor_b32 v245, 16, v254
    ds_write_b128 v245, v[180:183]
    ds_read_b128 v[176:179], v255 offset:0
    ds_read_b128 v[180:183], v255 offset:1024
    v_pk_mul_f32 v[48:49], v[48:49], v[252:253] op_sel_hi:[1,0]
    v_pk_mul_f32 v[50:51], v[50:51], v[252:253] op_sel_hi:[1,0]
    v_pk_mul_f32 v[52:53], v[52:53], v[252:253] op_sel_hi:[1,0]
    v_pk_mul_f32 v[54:55], v[54:55], v[252:253] op_sel_hi:[1,0]
    v_cvt_pk_bf16_f32 v184, v48, v49
    v_cvt_pk_bf16_f32 v185, v50, v51
    v_cvt_pk_bf16_f32 v186, v52, v53
    v_cvt_pk_bf16_f32 v187, v54, v55
    s_waitcnt lgkmcnt(1)
    buffer_store_dwordx4 v[176:179], v251, s[24:27], s32 offen offset:128 sc1
    s_waitcnt lgkmcnt(0)
    buffer_store_dwordx4 v[180:183], v251, s[24:27], s42 offen offset:128 sc1
    ds_write_b128 v254, v[184:187]
    v_pk_mul_f32 v[56:57], v[56:57], v[252:253] op_sel_hi:[1,0]
    v_pk_mul_f32 v[58:59], v[58:59], v[252:253] op_sel_hi:[1,0]
    v_pk_mul_f32 v[60:61], v[60:61], v[252:253] op_sel_hi:[1,0]
    v_pk_mul_f32 v[62:63], v[62:63], v[252:253] op_sel_hi:[1,0]
    v_cvt_pk_bf16_f32 v188, v56, v57
    v_cvt_pk_bf16_f32 v189, v58, v59
    v_cvt_pk_bf16_f32 v190, v60, v61
    v_cvt_pk_bf16_f32 v191, v62, v63
    v_xor_b32 v245, 16, v254
    ds_write_b128 v245, v[188:191]
    ds_read_b128 v[184:187], v255 offset:0
    ds_read_b128 v[188:191], v255 offset:1024
    s_waitcnt lgkmcnt(1)
    buffer_store_dwordx4 v[184:187], v251, s[24:27], s32 offen offset:192 sc1
    s_waitcnt lgkmcnt(0)
    buffer_store_dwordx4 v[188:191], v251, s[24:27], s42 offen offset:192 sc1

    s_endpgm
.section .rodata,"a"
.p2align 6
.amdhsa_kernel standalone__gqa_softmax__near_ridge_kernel
  .amdhsa_next_free_vgpr 512
  .amdhsa_next_free_sgpr 102
  .amdhsa_accum_offset 256
  .amdhsa_group_segment_fixed_size 0
  .amdhsa_kernarg_size 48
  .amdhsa_user_sgpr_count 2
  .amdhsa_user_sgpr_kernarg_segment_ptr 1
  .amdhsa_system_sgpr_workgroup_id_x 1
.end_amdhsa_kernel
```
